```python
import torch

def _softmax(x, axis=-1):
    return torch.softmax(x, dim=axis)
def _gelu(x):
    return torch.nn.functional.gelu(x, approximate="tanh")
def _silu(x):
    return torch.nn.functional.silu(x)
def _sigmoid(x):
    return torch.sigmoid(x)
def _layernorm(x, axis=-1, eps=1e-5):
    m = x.mean(dim=axis, keepdim=True)
    v = x.var(dim=axis, keepdim=True, unbiased=False)
    return (x - m) / torch.sqrt(v + eps)
def _scatter_add(tgt, idx, src, axis=0):
    return tgt.clone().index_add_(axis, idx, src)
def _segment_sum(src, seg, n):
    out = torch.zeros((n,) + src.shape[1:], dtype=src.dtype)
    return out.index_add_(0, seg, src)
def _pad(x, pw):
    flat = tuple(v for pair in reversed(pw) for v in pair)
    return torch.nn.functional.pad(x, flat)

kernel_name = 'concat_heads__ssm_conv_h3__ssm_conv_h3__prompt'

def setup_inputs():

    _w = (lambda a: (lambda t: t.to(torch.bfloat16) if t.is_floating_point() else t)(torch.as_tensor(a)))
    def _A_setup():
        B, S, D = 1, 2048, 640
        ks = 4
        return {
            "q": _w((lambda *s: torch.randn(*s, dtype=torch.bfloat16) * 0.05)(B, S, D)),
            "k": _w((lambda *s: torch.randn(*s, dtype=torch.bfloat16) * 0.05)(B, S, D)),
            "v": _w((lambda *s: torch.randn(*s, dtype=torch.bfloat16) * 0.05)(B, S, D)),
            "shift_k": _w((lambda *s: torch.randn(*s, dtype=torch.bfloat16) * 0.05)(D, ks) * 0.5),
            "ssm_k": _w((lambda *s: torch.randn(*s, dtype=torch.bfloat16) * 0.05)(D, S) * (1.0 / S ** 0.5)),
            "ssm_D": _w((lambda *s: torch.randn(*s, dtype=torch.bfloat16) * 0.05)(D)),
        }
    _A_in = _A_setup()

    def _B_setup():
        B, S, D = 1, 2048, 640
        ks = 4
        return {
            "q": _w((lambda *s: torch.randn(*s, dtype=torch.bfloat16) * 0.05)(B, S, D)),
            "k": _w((lambda *s: torch.randn(*s, dtype=torch.bfloat16) * 0.05)(B, S, D)),
            "v": _w((lambda *s: torch.randn(*s, dtype=torch.bfloat16) * 0.05)(B, S, D)),
            "shift_k": _w((lambda *s: torch.randn(*s, dtype=torch.bfloat16) * 0.05)(D, ks) * 0.5),
            "ssm_k": _w((lambda *s: torch.randn(*s, dtype=torch.bfloat16) * 0.05)(D, S) * (1.0 / S ** 0.5)),
            "ssm_D": _w((lambda *s: torch.randn(*s, dtype=torch.bfloat16) * 0.05)(D)),
        }
    _B_in = _B_setup()

    return {
        "A_q": _A_in["q"],
        "A_k": _A_in["k"],
        "A_v": _A_in["v"],
        "A_shift_k": _A_in["shift_k"],
        "A_ssm_k": _A_in["ssm_k"],
        "A_ssm_D": _A_in["ssm_D"],
        "B_q": _B_in["q"],
        "B_k": _B_in["k"],
        "B_v": _B_in["v"],
        "B_shift_k": _B_in["shift_k"],
        "B_ssm_k": _B_in["ssm_k"],
        "B_ssm_D": _B_in["ssm_D"],
    }

def reference(A_q, A_k, A_v, A_shift_k, A_ssm_k, A_ssm_D, B_q, B_k, B_v, B_shift_k, B_ssm_k, B_ssm_D):
    def _A_ref(q, k, v, shift_k, ssm_k, ssm_D):
        B, S, D = q.shape
        ks = shift_k.shape[-1]
        k_pad = _pad(k, ((0, 0), (ks - 1, 0), (0, 0)))
        k_shift = torch.zeros_like(k)
        for t in range(ks):
            k_shift = k_shift + k_pad[:, t:t + S, :] * shift_k[:, ks - 1 - t][None, None, :]
        kv = k_shift * v
        L = 2 * S
        kv_pad = _pad(kv, ((0, 0), (0, S), (0, 0)))
        kf_pad = _pad(ssm_k, ((0, 0), (0, S)))
        kv_f = (lambda x, axes=(-2,-1): torch.fft.rfft2(x.float(), dim=axes))(kv_pad[:, None, :, :], axes=(1, 2))
        kf_f = (lambda x, axes=(-2,-1): torch.fft.rfft2(x.float(), dim=axes))(kf_pad[:, None, :], axes=(1, 2))
        kf_f = (lambda x, *d: x.permute(*d))(kf_f, 1, 2, 0)
        y_f = kv_f * kf_f[None, :, :, :]
        y = (lambda x, s, axes=(-2,-1): torch.fft.irfft2(x, s=s, dim=axes).to(torch.bfloat16))(y_f, (1, L), axes=(1, 2))[:, 0, :S, :]
        y = y + kv * ssm_D[None, None, :]
        return q * y

    def _B_ref(q, k, v, shift_k, ssm_k, ssm_D):
        B, S, D = q.shape
        ks = shift_k.shape[-1]
        k_pad = _pad(k, ((0, 0), (ks - 1, 0), (0, 0)))
        k_shift = torch.zeros_like(k)
        for t in range(ks):
            k_shift = k_shift + k_pad[:, t:t + S, :] * shift_k[:, ks - 1 - t][None, None, :]
        kv = k_shift * v
        L = 2 * S
        kv_pad = _pad(kv, ((0, 0), (0, S), (0, 0)))
        kf_pad = _pad(ssm_k, ((0, 0), (0, S)))
        kv_f = (lambda x, axes=(-2,-1): torch.fft.rfft2(x.float(), dim=axes))(kv_pad[:, None, :, :], axes=(1, 2))
        kf_f = (lambda x, axes=(-2,-1): torch.fft.rfft2(x.float(), dim=axes))(kf_pad[:, None, :], axes=(1, 2))
        kf_f = (lambda x, *d: x.permute(*d))(kf_f, 1, 2, 0)
        y_f = kv_f * kf_f[None, :, :, :]
        y = (lambda x, s, axes=(-2,-1): torch.fft.irfft2(x, s=s, dim=axes).to(torch.bfloat16))(y_f, (1, L), axes=(1, 2))[:, 0, :S, :]
        y = y + kv * ssm_D[None, None, :]
        return q * y

    a = _A_ref(A_q, A_k, A_v, A_shift_k, A_ssm_k, A_ssm_D)
    b = _B_ref(B_q, B_k, B_v, B_shift_k, B_ssm_k, B_ssm_D)
    return torch.concatenate([a, b], axis=-1)
```

```asm
; @launch grid=(256,1,1) block=(1024,1,1) lds=152832
.amdgcn_target "amdgcn-amd-amdhsa--gfx950"
.text
.globl concat_heads__ssm_conv_h3__ssm_conv_h3__prompt_kernel
.p2align 8
.type concat_heads__ssm_conv_h3__ssm_conv_h3__prompt_kernel,@function
concat_heads__ssm_conv_h3__ssm_conv_h3__prompt_kernel:
    s_cmp_ge_u32 s2, 256
    s_cbranch_scc1 L_end
    v_lshrrev_b32 v1, 6, v0
    s_and_b32 s4, s2, 7
    s_lshr_b32 s5, s2, 3
    v_readfirstlane_b32 s3, v1
    v_and_b32 v0, 63, v0
    s_xor_b32 s3, s3, 8
    s_lshr_b32 s6, s4, 2
    s_mul_i32 s7, s6, 48
    s_add_u32 s8, s0, s7
    s_addc_u32 s9, s1, 0
    s_load_dwordx4 s[28:31], s[8:9], 0
    s_load_dwordx4 s[32:35], s[8:9], 16
    s_load_dwordx4 s[36:39], s[8:9], 32
    s_load_dwordx2 s[24:25], s[0:1], 96
    s_and_b32 s7, s4, 3
    s_mul_i32 s7, s7, 160
    s_lshl_b32 s10, s5, 3
    s_lshl_b32 s11, s5, 4
    s_sub_u32 s11, s11, 320
    s_cmp_ge_u32 s5, 20
    s_cselect_b32 s10, s11, s10
    s_cselect_b32 s89, 1, 0
    s_add_u32 s10, s10, s7
    s_lshl_b32 s88, s7, 1
    s_and_b32 s88, s88, 0xffffff80
    s_cmp_ge_u32 s5, 30
    s_cbranch_scc1 L_pf
    v_lshlrev_b32 v1, 2, v0
    v_and_b32 v1, 124, v1
    v_add_u32 v1, 152704, v1
    v_mov_b32 v2, 0
    ds_write_b32 v1, v2
    s_cmp_lt_u32 s3, 8
    s_cbranch_scc1 L_io
L_mfma:
    s_sub_u32 s3, s3, 8
    s_add_u32 s7, s10, s3
    s_lshl_b32 s11, s7, 12
    s_lshr_b32 s44, s7, 1
    s_lshl_b32 s44, s44, 2
    s_and_b32 s45, s7, 1
    v_lshlrev_b32 v1, 4, v0
    v_subrev_u32 v2, 4, v1
    s_cmp_lg_u32 s89, 0
    s_cselect_b32 s7, 32768, 0
    s_cselect_b32 s22, 0, 2048
    s_mov_b32 s23, 4576
    s_cmov_b32 s23, 2528
    s_mov_b32 s49, 4224
    s_cmov_b32 s49, 2176
    s_mov_b32 s50, 2048
    s_cmov_b32 s50, 5056
    v_add_u32 v3, s22, v1
    v_subrev_u32 v4, 4, v3
    s_waitcnt lgkmcnt(0)
    s_add_u32 s12, s36, s11
    s_addc_u32 s13, s37, 0
    s_and_b32 s13, s13, 0xffff
    s_mov_b32 s14, 4096
    s_mov_b32 s15, 0x20000
    s_add_u32 s16, s12, s7
    s_addc_u32 s17, s13, 0
    s_mov_b32 s18, 4096
    s_mov_b32 s19, 0x20000
    s_add_u32 s38, s38, s44
    s_addc_u32 s39, s39, 0
    s_load_dword s40, s[38:39], 0
    s_cmp_lg_u32 s89, 0
    s_cselect_b32 s7, 16, 0
    s_load_dword s41, s[38:39], s7
    s_setprio 3
    buffer_load_dwordx4 v[48:51], v1, s[12:15], 0 offen offset:0
    buffer_load_dwordx4 v[52:55], v1, s[12:15], 0 offen offset:1024
    buffer_load_dwordx4 v[56:59], v3, s[16:19], 0 offen offset:0
    buffer_load_dwordx4 v[60:63], v3, s[16:19], 0 offen offset:1024
    s_setprio 0
    s_mul_i32 s20, s3, 10112
    s_and_b32 s7, s3, 3
    s_mul_i32 s21, s7, 8960
    s_lshr_b32 s7, s3, 2
    s_mul_i32 s7, s7, 35904
    s_add_u32 s21, s21, s7
    s_add_u32 s21, s21, 80896
    v_mov_b32 v4, 0
    v_mov_b32 v5, 0
    v_mov_b32 v6, 0
    v_mov_b32 v7, 0
    v_and_b32 v3, 31, v0
    v_min_u32 v3, 27, v3
    v_lshlrev_b32 v3, 4, v3
    v_lshrrev_b32 v8, 5, v0
    v_mul_u32_u24 v9, s23, v8
    v_add3_u32 v3, v3, v9, s20
    ds_write_b128 v3, v[4:7]
    v_and_b32 v10, 31, v0
    v_min_u32 v10, 16, v10
    v_lshlrev_b32 v10, 2, v10
    s_add_u32 s7, s49, 4
    v_mul_u32_u24 v9, s7, v8
    v_sub_u32 v10, v10, v9
    s_lshl_b32 s7, s49, 1
    s_add_u32 s7, s7, s21
    s_add_u32 s7, s7, -112
    v_add_u32 v10, s7, v10
    ds_write_b32 v10, v4
    s_cmp_eq_u32 s89, 0
    s_cbranch_scc1 L_nopad2
    ds_write_b128 v3, v[4:7] offset:5056
    ds_write_b32 v10, v4 offset:4384
L_nopad2:
    v_add_u32 v40, s20, v1
    v_add_u32 v46, s50, v40
    v_add_u32 v47, s23, v40
    v_add_u32 v76, s23, v46
    v_and_b32 v41, 1, v0
    v_xor_b32 v41, 1, v41
    v_mul_u32_u24 v41, s23, v41
    v_bfe_u32 v42, v0, 1, 3
    v_lshlrev_b32 v42, 6, v42
    v_lshrrev_b32 v43, 4, v0
    v_lshlrev_b32 v44, 4, v43
    v_add3_u32 v41, v41, v42, v44
    v_add_u32 v1, s20, v41
    v_and_b32 v41, 1, v0
    s_add_u32 s7, s49, 4
    v_mul_u32_u24 v41, s7, v41
    v_and_b32 v42, 15, v0
    v_lshlrev_b32 v45, 2, v42
    v_sub_u32 v41, v41, v45
    v_add3_u32 v41, v41, v44, s21
    v_add_u32 v2, 72, v41
    v_lshlrev_b32 v41, 8, v43
    v_lshlrev_b32 v45, 3, v42
    v_add3_u32 v41, v41, v45, s21
    v_add_u32 v3, 80, v41
    v_mov_b32 v8, 0
    v_mov_b32 v9, 0
    v_mov_b32 v10, 0
    v_mov_b32 v11, 0
    v_mov_b32 v12, 0
    v_mov_b32 v13, 0
    v_mov_b32 v14, 0
    v_mov_b32 v15, 0
    v_mov_b32 v16, 0
    v_mov_b32 v17, 0
    v_mov_b32 v18, 0
    v_mov_b32 v19, 0
    v_mov_b32 v20, 0
    v_mov_b32 v21, 0
    v_mov_b32 v22, 0
    v_mov_b32 v23, 0
    v_mov_b32 v24, 0
    v_mov_b32 v25, 0
    v_mov_b32 v26, 0
    v_mov_b32 v27, 0
    v_mov_b32 v28, 0
    v_mov_b32 v29, 0
    v_mov_b32 v30, 0
    v_mov_b32 v31, 0
    v_mov_b32 v32, 0
    v_mov_b32 v33, 0
    v_mov_b32 v34, 0
    v_mov_b32 v35, 0
    v_mov_b32 v36, 0
    v_mov_b32 v37, 0
    v_mov_b32 v38, 0
    v_mov_b32 v39, 0
    s_waitcnt lgkmcnt(0)
    s_lshl_b32 s42, s40, 16
    s_and_b32 s40, s40, 0xffff0000
    s_lshl_b32 s43, s41, 16
    s_and_b32 s41, s41, 0xffff0000
    s_cmp_eq_u32 s45, 0
    s_cselect_b32 s40, s42, s40
    s_cselect_b32 s41, s43, s41
    s_cmp_eq_u32 s89, 0
    s_cselect_b32 s41, 0, s41
    v_mov_b32 v64, 0
    s_waitcnt vmcnt(3)
    s_nop 0
    v_mov_b32_dpp v64, v51 wave_shr:1 row_mask:0xf bank_mask:0xf
    s_mov_b64 exec, 1
    v_lshlrev_b32 v77, 16, v48
    v_and_b32 v78, 0xffff0000, v48
    v_add_f32 v77, s40, v77
    v_cvt_pk_bf16_f32 v48, v77, v78
    s_mov_b64 exec, -1
    ds_write_b128 v40, v[48:51] offset:448
    v_alignbit_b32 v68, v48, v64, 16
    v_alignbit_b32 v69, v49, v48, 16
    v_alignbit_b32 v70, v50, v49, 16
    v_alignbit_b32 v71, v51, v50, 16
    ds_write_b128 v47, v[68:71] offset:448
    v_readlane_b32 s46, v51, 63
    s_nop 1
    v_mov_b32 v65, s46
    s_waitcnt vmcnt(2)
    s_nop 0
    v_mov_b32_dpp v65, v55 wave_shr:1 row_mask:0xf bank_mask:0xf
    ds_write_b128 v40, v[52:55] offset:1472
    v_alignbit_b32 v72, v52, v65, 16
    v_alignbit_b32 v73, v53, v52, 16
    v_alignbit_b32 v74, v54, v53, 16
    v_alignbit_b32 v75, v55, v54, 16
    ds_write_b128 v47, v[72:75] offset:1472
    v_readlane_b32 s46, v55, 63
    s_cmp_eq_u32 s89, 0
    s_cselect_b32 s46, s46, 0
    v_mov_b32 v66, s46
    s_waitcnt vmcnt(1)
    s_nop 0
    v_mov_b32_dpp v66, v59 wave_shr:1 row_mask:0xf bank_mask:0xf
    s_mov_b64 exec, 1
    v_lshlrev_b32 v77, 16, v56
    v_and_b32 v78, 0xffff0000, v56
    v_add_f32 v77, s41, v77
    v_cvt_pk_bf16_f32 v56, v77, v78
    s_mov_b64 exec, -1
    ds_write_b128 v46, v[56:59] offset:448
    v_alignbit_b32 v68, v56, v66, 16
    v_alignbit_b32 v69, v57, v56, 16
    v_alignbit_b32 v70, v58, v57, 16
    v_alignbit_b32 v71, v59, v58, 16
    ds_write_b128 v76, v[68:71] offset:448
    v_readlane_b32 s46, v59, 63
    s_nop 1
    v_mov_b32 v67, s46
    s_waitcnt vmcnt(0)
    s_nop 0
    v_mov_b32_dpp v67, v63 wave_shr:1 row_mask:0xf bank_mask:0xf
    ds_write_b128 v46, v[60:63] offset:1472
    v_alignbit_b32 v72, v60, v67, 16
    v_alignbit_b32 v73, v61, v60, 16
    v_alignbit_b32 v74, v62, v61, 16
    v_alignbit_b32 v75, v63, v62, 16
    ds_write_b128 v76, v[72:75] offset:1472
    v_mov_b32 v4, 152704
    v_mov_b32 v5, 1
    s_waitcnt lgkmcnt(0)
    s_barrier
    s_cmp_lg_u32 s89, 0
    s_cbranch_scc1 L_mfma_h
    s_branch L_mfma_m
L_io:
    s_setprio 3
    s_cmp_lg_u32 s89, 0
    s_cselect_b32 s40, 2, 1
    s_mov_b32 s41, 128
    s_cmov_b32 s41, 64
    s_mov_b32 s42, 196611
    s_cmov_b32 s42, 983055
    s_mov_b32 s43, s42
    s_mov_b32 s49, 4224
    s_cmov_b32 s49, 2176
    s_mov_b32 s50, 89224
    s_cmov_b32 s50, 85128
    s_cselect_b32 s44, 1, 2
    s_cselect_b32 s45, 3, 1
    v_lshrrev_b32 v5, s40, v0
    v_and_b32 v6, s45, v0
    v_mul_u32_u24 v1, 5120, v5
    v_lshlrev_b32 v7, 3, v6
    s_lshl_b32 s7, s10, 1
    v_add3_u32 v1, v1, v7, s7
    v_lshlrev_b32 v8, 5, v6
    s_lshl_b32 s7, s10, 3
    v_add_u32 v8, s7, v8
    s_waitcnt lgkmcnt(0)
    s_mov_b32 s12, s30
    s_and_b32 s13, s31, 0xffff
    s_mov_b32 s14, 2621440
    s_mov_b32 s15, 0x20000
    s_mov_b32 s16, s32
    s_and_b32 s17, s33, 0xffff
    s_mov_b32 s18, 2621440
    s_mov_b32 s19, 0x20000
    s_mov_b32 s20, s28
    s_and_b32 s21, s29, 0xffff
    s_mov_b32 s22, 2621440
    s_mov_b32 s23, 0x20000
    s_mov_b32 s52, s34
    s_and_b32 s53, s35, 0xffff
    s_mov_b32 s54, 5120
    s_mov_b32 s55, 0x20000
    s_cmp_lt_u32 s3, 4
    s_cbranch_scc1 L_nobar1
    s_barrier
L_nobar1:
    buffer_load_dwordx4 v[10:13], v8, s[52:55], 0 offen
    buffer_load_dwordx4 v[14:17], v8, s[52:55], 0 offen offset:16
    s_mov_b32 s46, s3
    s_mul_i32 s7, s46, s41
    s_mul_i32 s7, s7, 1280
    v_add_u32 v7, s7, v1
    v_subrev_u32 v8, 3840, v7
    s_and_b32 s7, s5, 1
    s_cmp_eq_u32 s7, 1
    s_cbranch_scc1 L_rot_1_1
    buffer_load_dwordx2 v[40:41], v7, s[12:15], 0 offen offset:0
    buffer_load_dwordx2 v[42:43], v7, s[12:15], 0 offen offset:1280
    buffer_load_dwordx2 v[44:45], v7, s[12:15], 0 offen offset:2560
    buffer_load_dwordx2 v[46:47], v7, s[12:15], 0 offen offset:3840
    s_mov_b64 exec, s[42:43]
    buffer_load_dwordx2 v[34:35], v8, s[12:15], 0 offen offset:0
    buffer_load_dwordx2 v[36:37], v8, s[12:15], 0 offen offset:1280
    buffer_load_dwordx2 v[38:39], v8, s[12:15], 0 offen offset:2560
    s_mov_b64 exec, -1
    buffer_load_dwordx2 v[48:49], v7, s[16:19], 0 offen offset:0
    buffer_load_dwordx2 v[50:51], v7, s[16:19], 0 offen offset:1280
    buffer_load_dwordx2 v[52:53], v7, s[16:19], 0 offen offset:2560
    buffer_load_dwordx2 v[54:55], v7, s[16:19], 0 offen offset:3840
    s_branch L_rot_1_end
L_rot_1_1:
    buffer_load_dwordx2 v[44:45], v7, s[12:15], 0 offen offset:2560
    buffer_load_dwordx2 v[46:47], v7, s[12:15], 0 offen offset:3840
    buffer_load_dwordx2 v[40:41], v7, s[12:15], 0 offen offset:0
    buffer_load_dwordx2 v[42:43], v7, s[12:15], 0 offen offset:1280
    s_mov_b64 exec, s[42:43]
    buffer_load_dwordx2 v[34:35], v8, s[12:15], 0 offen offset:0
    buffer_load_dwordx2 v[36:37], v8, s[12:15], 0 offen offset:1280
    buffer_load_dwordx2 v[38:39], v8, s[12:15], 0 offen offset:2560
    s_mov_b64 exec, -1
    buffer_load_dwordx2 v[52:53], v7, s[16:19], 0 offen offset:2560
    buffer_load_dwordx2 v[54:55], v7, s[16:19], 0 offen offset:3840
    buffer_load_dwordx2 v[48:49], v7, s[16:19], 0 offen offset:0
    buffer_load_dwordx2 v[50:51], v7, s[16:19], 0 offen offset:1280
L_rot_1_end:
    s_cmp_ge_u32 s3, 4
    s_cbranch_scc1 L_nobar2
    s_barrier
L_nobar2:
    s_mov_b32 s58, 0
    s_and_b32 s25, s25, 0xffff
    s_mov_b32 s26, 5242880
    s_mov_b32 s27, 0x20000
    v_mul_u32_u24 v2, 10240, v5
    s_mul_i32 s7, s6, 1280
    s_lshl_b32 s11, s10, 1
    s_add_u32 s7, s7, s11
    v_lshlrev_b32 v56, 3, v6
    v_add3_u32 v2, v2, v56, s7
    v_and_b32 v56, 1, v6
    v_mul_u32_u24 v56, 35904, v56
    v_lshrrev_b32 v57, 1, v6
    v_mul_u32_u24 v57, 4384, v57
    v_add_u32 v56, v56, v57
    v_lshlrev_b32 v57, 3, v5
    v_sub_u32 v3, v56, v57
    v_add_u32 v3, s50, v3
    v_lshlrev_b32 v57, 4, v5
    v_add_u32 v4, v56, v57
    v_add_u32 v4, 80976, v4
    s_mov_b32 s48, 0xffff0000
    s_waitcnt vmcnt(11)
    v_lshlrev_b32 v18, 16, v10
    v_and_b32 v19, s48, v10
    v_lshlrev_b32 v20, 16, v11
    v_and_b32 v21, s48, v11
    v_lshlrev_b32 v22, 16, v12
    v_and_b32 v23, s48, v12
    v_lshlrev_b32 v24, 16, v13
    v_and_b32 v25, s48, v13
    v_lshlrev_b32 v26, 16, v14
    v_and_b32 v27, s48, v14
    v_lshlrev_b32 v28, 16, v15
    v_and_b32 v29, s48, v15
    v_lshlrev_b32 v30, 16, v16
    v_and_b32 v31, s48, v16
    v_lshlrev_b32 v32, 16, v17
    v_and_b32 v33, s48, v17
    s_mov_b32 s47, 0
L_xjob:
    s_mul_i32 s7, s46, s41
    s_lshl_b32 s11, s7, 1
    v_subrev_u32 v5, s11, v3
    v_subrev_u32 v6, s49, v5
    v_subrev_u32 v9, 4, v6
    s_lshr_b32 s7, s7, 8
    s_lshl_b32 s7, s7, 2
    s_add_u32 s51, s7, 152704
    s_or_b32 s59, s47, s58
    s_mov_b32 s58, 0
    s_waitcnt vmcnt(7)
    s_cmp_eq_u32 s59, 2
    s_cbranch_scc1 L_w1
    s_waitcnt vmcnt(4)
L_w1:
    s_setprio 3
    s_cmp_lg_u32 s89, 0
    s_cbranch_scc1 L_dpp_h
    v_mov_b32_dpp v34, v42 row_shr:2 row_mask:0xf bank_mask:0xf
    v_mov_b32_dpp v35, v43 row_shr:2 row_mask:0xf bank_mask:0xf
    v_mov_b32_dpp v36, v44 row_shr:2 row_mask:0xf bank_mask:0xf
    v_mov_b32_dpp v37, v45 row_shr:2 row_mask:0xf bank_mask:0xf
    v_mov_b32_dpp v38, v46 row_shr:2 row_mask:0xf bank_mask:0xf
    v_mov_b32_dpp v39, v47 row_shr:2 row_mask:0xf bank_mask:0xf
    s_branch L_dpp_done
L_dpp_h:
    v_mov_b32_dpp v34, v42 row_shr:4 row_mask:0xf bank_mask:0xf
    v_mov_b32_dpp v35, v43 row_shr:4 row_mask:0xf bank_mask:0xf
    v_mov_b32_dpp v36, v44 row_shr:4 row_mask:0xf bank_mask:0xf
    v_mov_b32_dpp v37, v45 row_shr:4 row_mask:0xf bank_mask:0xf
    v_mov_b32_dpp v38, v46 row_shr:4 row_mask:0xf bank_mask:0xf
    v_mov_b32_dpp v39, v47 row_shr:4 row_mask:0xf bank_mask:0xf
L_dpp_done:
    v_lshlrev_b32 v59, 16, v40
    v_and_b32 v66, s48, v40
    v_lshlrev_b32 v60, 16, v42
    v_and_b32 v67, s48, v42
    v_lshlrev_b32 v61, 16, v44
    v_and_b32 v68, s48, v44
    v_lshlrev_b32 v62, 16, v46
    v_and_b32 v69, s48, v46
    v_lshlrev_b32 v56, 16, v34
    v_and_b32 v63, s48, v34
    v_lshlrev_b32 v57, 16, v36
    v_and_b32 v64, s48, v36
    v_lshlrev_b32 v58, 16, v38
    v_and_b32 v65, s48, v38
    v_mul_f32 v70, v21, v56
    v_mul_f32 v71, v21, v57
    v_mul_f32 v72, v21, v58
    v_mul_f32 v73, v21, v59
    v_fmac_f32 v70, v20, v57
    v_fmac_f32 v71, v20, v58
    v_fmac_f32 v72, v20, v59
    v_fmac_f32 v73, v20, v60
    v_fmac_f32 v70, v19, v58
    v_fmac_f32 v71, v19, v59
    v_fmac_f32 v72, v19, v60
    v_fmac_f32 v73, v19, v61
    v_fmac_f32 v70, v18, v59
    v_fmac_f32 v71, v18, v60
    v_fmac_f32 v72, v18, v61
    v_fmac_f32 v73, v18, v62
    v_mul_f32 v74, v25, v63
    v_mul_f32 v75, v25, v64
    v_mul_f32 v76, v25, v65
    v_mul_f32 v77, v25, v66
    v_fmac_f32 v74, v24, v64
    v_fmac_f32 v75, v24, v65
    v_fmac_f32 v76, v24, v66
    v_fmac_f32 v77, v24, v67
    v_fmac_f32 v74, v23, v65
    v_fmac_f32 v75, v23, v66
    v_fmac_f32 v76, v23, v67
    v_fmac_f32 v77, v23, v68
    v_fmac_f32 v74, v22, v66
    v_fmac_f32 v75, v22, v67
    v_fmac_f32 v76, v22, v68
    v_fmac_f32 v77, v22, v69
    v_lshlrev_b32 v59, 16, v41
    v_and_b32 v66, s48, v41
    v_lshlrev_b32 v60, 16, v43
    v_and_b32 v67, s48, v43
    v_lshlrev_b32 v61, 16, v45
    v_and_b32 v68, s48, v45
    v_lshlrev_b32 v62, 16, v47
    v_and_b32 v69, s48, v47
    v_lshlrev_b32 v56, 16, v35
    v_and_b32 v63, s48, v35
    v_lshlrev_b32 v57, 16, v37
    v_and_b32 v64, s48, v37
    v_lshlrev_b32 v58, 16, v39
    v_and_b32 v65, s48, v39
    v_mul_f32 v78, v29, v56
    v_mul_f32 v79, v29, v57
    v_mul_f32 v80, v29, v58
    v_mul_f32 v81, v29, v59
    v_fmac_f32 v78, v28, v57
    v_fmac_f32 v79, v28, v58
    v_fmac_f32 v80, v28, v59
    v_fmac_f32 v81, v28, v60
    v_fmac_f32 v78, v27, v58
    v_fmac_f32 v79, v27, v59
    v_fmac_f32 v80, v27, v60
    v_fmac_f32 v81, v27, v61
    v_fmac_f32 v78, v26, v59
    v_fmac_f32 v79, v26, v60
    v_fmac_f32 v80, v26, v61
    v_fmac_f32 v81, v26, v62
    v_mul_f32 v82, v33, v63
    v_mul_f32 v83, v33, v64
    v_mul_f32 v84, v33, v65
    v_mul_f32 v85, v33, v66
    v_fmac_f32 v82, v32, v64
    v_fmac_f32 v83, v32, v65
    v_fmac_f32 v84, v32, v66
    v_fmac_f32 v85, v32, v67
    v_fmac_f32 v82, v31, v65
    v_fmac_f32 v83, v31, v66
    v_fmac_f32 v84, v31, v67
    v_fmac_f32 v85, v31, v68
    v_fmac_f32 v82, v30, v66
    v_fmac_f32 v83, v30, v67
    v_fmac_f32 v84, v30, v68
    v_fmac_f32 v85, v30, v69
    s_waitcnt vmcnt(3)
    s_cmp_eq_u32 s59, 2
    s_cbranch_scc1 L_w2
    s_waitcnt vmcnt(0)
L_w2:
    v_lshlrev_b32 v56, 16, v48
    v_and_b32 v60, s48, v48
    v_lshlrev_b32 v57, 16, v50
    v_and_b32 v61, s48, v50
    v_lshlrev_b32 v58, 16, v52
    v_and_b32 v62, s48, v52
    v_lshlrev_b32 v59, 16, v54
    v_and_b32 v63, s48, v54
    v_mul_f32 v70, v70, v56
    v_mul_f32 v71, v71, v57
    v_mul_f32 v72, v72, v58
    v_mul_f32 v73, v73, v59
    v_mul_f32 v74, v74, v60
    v_mul_f32 v75, v75, v61
    v_mul_f32 v76, v76, v62
    v_mul_f32 v77, v77, v63
    v_cvt_pk_bf16_f32 v86, v73, v72
    v_cvt_pk_bf16_f32 v87, v71, v70
    v_cvt_pk_bf16_f32 v88, v77, v76
    v_cvt_pk_bf16_f32 v89, v75, v74
    ds_write_b64 v5, v[86:87] offset:0
    ds_write_b64 v5, v[88:89] offset:8960
    ds_write2st64_b32 v9, v86, v88 offset0:0 offset1:35
    ds_write2st64_b32 v6, v87, v89 offset0:0 offset1:35
    v_lshlrev_b32 v56, 16, v49
    v_and_b32 v60, s48, v49
    v_lshlrev_b32 v57, 16, v51
    v_and_b32 v61, s48, v51
    v_lshlrev_b32 v58, 16, v53
    v_and_b32 v62, s48, v53
    v_lshlrev_b32 v59, 16, v55
    v_and_b32 v63, s48, v55
    v_mul_f32 v78, v78, v56
    v_mul_f32 v79, v79, v57
    v_mul_f32 v80, v80, v58
    v_mul_f32 v81, v81, v59
    v_mul_f32 v82, v82, v60
    v_mul_f32 v83, v83, v61
    v_mul_f32 v84, v84, v62
    v_mul_f32 v85, v85, v63
    v_cvt_pk_bf16_f32 v90, v81, v80
    v_cvt_pk_bf16_f32 v91, v79, v78
    v_cvt_pk_bf16_f32 v92, v85, v84
    v_cvt_pk_bf16_f32 v93, v83, v82
    ds_write_b64 v5, v[90:91] offset:17920
    ds_write_b64 v5, v[92:93] offset:26880
    ds_write2st64_b32 v9, v90, v92 offset0:70 offset1:105
    ds_write2st64_b32 v6, v91, v93 offset0:70 offset1:105
    v_mov_b32 v56, s51
    v_mov_b32 v57, s44
    s_waitcnt lgkmcnt(0)
    s_mov_b64 exec, 1
    ds_add_u32 v56, v57
    s_mov_b64 exec, -1
    s_cmp_lg_u32 s47, 0
    s_cbranch_scc1 L_xdone
    s_mov_b32 s47, 1
    s_setprio 2
    s_add_u32 s46, s3, 8
    s_mul_i32 s7, s46, s41
    s_mul_i32 s7, s7, 1280
    v_add_u32 v7, s7, v1
    v_subrev_u32 v8, 3840, v7
    s_and_b32 s7, s5, 1
    s_cmp_eq_u32 s7, 1
    s_cbranch_scc1 L_rot_2_1
    buffer_load_dwordx2 v[40:41], v7, s[12:15], 0 offen offset:0
    buffer_load_dwordx2 v[42:43], v7, s[12:15], 0 offen offset:1280
    buffer_load_dwordx2 v[44:45], v7, s[12:15], 0 offen offset:2560
    buffer_load_dwordx2 v[46:47], v7, s[12:15], 0 offen offset:3840
    s_mov_b64 exec, s[42:43]
    buffer_load_dwordx2 v[34:35], v8, s[12:15], 0 offen offset:0
    buffer_load_dwordx2 v[36:37], v8, s[12:15], 0 offen offset:1280
    buffer_load_dwordx2 v[38:39], v8, s[12:15], 0 offen offset:2560
    s_mov_b64 exec, -1
    buffer_load_dwordx2 v[48:49], v7, s[16:19], 0 offen offset:0
    buffer_load_dwordx2 v[50:51], v7, s[16:19], 0 offen offset:1280
    buffer_load_dwordx2 v[52:53], v7, s[16:19], 0 offen offset:2560
    buffer_load_dwordx2 v[54:55], v7, s[16:19], 0 offen offset:3840
    s_branch L_rot_2_end
L_rot_2_1:
    buffer_load_dwordx2 v[44:45], v7, s[12:15], 0 offen offset:2560
    buffer_load_dwordx2 v[46:47], v7, s[12:15], 0 offen offset:3840
    buffer_load_dwordx2 v[40:41], v7, s[12:15], 0 offen offset:0
    buffer_load_dwordx2 v[42:43], v7, s[12:15], 0 offen offset:1280
    s_mov_b64 exec, s[42:43]
    buffer_load_dwordx2 v[34:35], v8, s[12:15], 0 offen offset:0
    buffer_load_dwordx2 v[36:37], v8, s[12:15], 0 offen offset:1280
    buffer_load_dwordx2 v[38:39], v8, s[12:15], 0 offen offset:2560
    s_mov_b64 exec, -1
    buffer_load_dwordx2 v[52:53], v7, s[16:19], 0 offen offset:2560
    buffer_load_dwordx2 v[54:55], v7, s[16:19], 0 offen offset:3840
    buffer_load_dwordx2 v[48:49], v7, s[16:19], 0 offen offset:0
    buffer_load_dwordx2 v[50:51], v7, s[16:19], 0 offen offset:1280
L_rot_2_end:
    s_cmp_lt_u32 s3, 4
    s_cbranch_scc1 L_xjob
    s_cmp_eq_u32 s89, 0
    s_cbranch_scc1 L_xjob
    s_mul_i32 s56, s3, 10
    s_add_u32 s56, s56, s5
    s_sub_u32 s56, s56, 60
    s_mov_b32 s47, 2
    s_cmp_ge_u32 s56, 24
    s_cbranch_scc1 L_hpf_q
    s_lshl_b32 s7, s56, 6
    v_add_u32 v94, s7, v0
    s_mov_b32 s7, 0xAAAB
    v_mul_u32_u24 v95, s7, v94
    v_lshrrev_b32 v95, 17, v95
    v_mul_u32_u24 v96, 3, v95
    v_sub_u32 v96, v94, v96
    v_mul_u32_u24 v95, 1280, v95
    v_lshlrev_b32 v96, 7, v96
    s_add_u32 s7, s88, 1966080
    v_add3_u32 v94, v95, v96, s7
    buffer_load_dword v97, v94, s[12:15], 0 offen
    buffer_load_dword v98, v94, s[16:19], 0 offen
    s_mov_b64 exec, 1
    buffer_load_dword v99, v94, s[16:19], 0 offen
    s_mov_b64 exec, -1
    s_branch L_xjob
L_hpf_q:
    s_sub_u32 s56, s56, 24
    s_lshl_b32 s7, s56, 6
    v_add_u32 v94, s7, v0
    s_mov_b32 s7, 0xAAAB
    v_mul_u32_u24 v95, s7, v94
    v_lshrrev_b32 v95, 17, v95
    v_mul_u32_u24 v96, 3, v95
    v_sub_u32 v96, v94, v96
    v_mul_u32_u24 v95, 1280, v95
    v_lshlrev_b32 v96, 7, v96
    s_add_u32 s7, s88, 0
    v_add3_u32 v94, v95, v96, s7
    s_mov_b32 s7, 436480
    buffer_load_dword v97, v94, s[20:23], 0 offen
    buffer_load_dword v98, v94, s[20:23], s7 offen
    s_mov_b32 s7, 872960
    buffer_load_dword v99, v94, s[20:23], s7 offen
    s_branch L_xjob
L_xdone:
    s_setprio 1
    s_add_u32 s7, s3, 8
    s_cmp_lg_u32 s89, 0
    s_cselect_b32 s46, s3, s7
L_ejob:
    s_mul_i32 s56, s46, s41
    s_mul_i32 s7, s56, 1280
    v_add_u32 v7, s7, v1
    buffer_load_dwordx2 v[94:95], v7, s[20:23], 0 offen offset:0
    buffer_load_dwordx2 v[96:97], v7, s[20:23], 0 offen offset:1280
    buffer_load_dwordx2 v[98:99], v7, s[20:23], 0 offen offset:2560
    buffer_load_dwordx2 v[100:101], v7, s[20:23], 0 offen offset:3840
L_qskip:
    s_mul_i32 s7, s56, 2560
    v_add_u32 v7, s7, v2
    v_add_u32 v8, 5120, v7
    s_and_b32 s7, s56, 255
    s_lshl_b32 s7, s7, 2
    s_bitcmp1_b32 s56, 8
    s_cselect_b32 s11, s49, 0
    s_add_u32 s7, s7, s11
    s_bitcmp1_b32 s56, 9
    s_cselect_b32 s11, 0, 1024
    s_add_u32 s7, s7, s11
    v_add_u32 v5, s7, v4
    s_lshr_b32 s7, s56, 9
    s_lshl_b32 s7, s7, 2
    s_add_u32 s7, s7, 152736
    v_mov_b32 v6, s7
    s_waitcnt vmcnt(0)
    s_setprio 3
    v_lshlrev_b32 v102, 16, v94
    v_and_b32 v106, s48, v94
    v_lshlrev_b32 v110, 16, v95
    v_and_b32 v114, s48, v95
    v_lshlrev_b32 v103, 16, v96
    v_and_b32 v107, s48, v96
    v_lshlrev_b32 v111, 16, v97
    v_and_b32 v115, s48, v97
    v_lshlrev_b32 v104, 16, v98
    v_and_b32 v108, s48, v98
    v_lshlrev_b32 v112, 16, v99
    v_and_b32 v116, s48, v99
    v_lshlrev_b32 v105, 16, v100
    v_and_b32 v109, s48, v100
    v_lshlrev_b32 v113, 16, v101
    v_and_b32 v117, s48, v101
    s_mov_b64 exec, 1
L_ywait_3:
    ds_read_b32 v56, v6
    s_waitcnt lgkmcnt(0)
    v_readfirstlane_b32 s7, v56
    s_cmp_ge_u32 s7, 8
    s_cbranch_scc1 L_ywait_3_done
    s_cmp_lg_u32 s7, 0
    s_cbranch_scc1 L_ywait_3_s
    s_sleep 8
L_ywait_3_s:
    s_sleep 1
    s_branch L_ywait_3
L_ywait_3_done:
    s_mov_b64 exec, -1
    ds_read_b128 v[56:59], v5 offset:0
    ds_read_b128 v[60:63], v5 offset:8960
    ds_read_b128 v[64:67], v5 offset:17920
    ds_read_b128 v[68:71], v5 offset:26880
    s_waitcnt lgkmcnt(2)
    v_mul_f32 v56, v56, v102
    v_mul_f32 v57, v57, v103
    v_mul_f32 v58, v58, v104
    v_mul_f32 v59, v59, v105
    v_mul_f32 v60, v60, v106
    v_mul_f32 v61, v61, v107
    v_mul_f32 v62, v62, v108
    v_mul_f32 v63, v63, v109
    v_cvt_pk_bf16_f32 v72, v56, v60
    v_cvt_pk_bf16_f32 v74, v57, v61
    v_cvt_pk_bf16_f32 v76, v58, v62
    v_cvt_pk_bf16_f32 v78, v59, v63
    s_waitcnt lgkmcnt(0)
    v_mul_f32 v64, v64, v110
    v_mul_f32 v65, v65, v111
    v_mul_f32 v66, v66, v112
    v_mul_f32 v67, v67, v113
    v_mul_f32 v68, v68, v114
    v_mul_f32 v69, v69, v115
    v_mul_f32 v70, v70, v116
    v_mul_f32 v71, v71, v117
    v_cvt_pk_bf16_f32 v73, v64, v68
    v_cvt_pk_bf16_f32 v75, v65, v69
    v_cvt_pk_bf16_f32 v77, v66, v70
    v_cvt_pk_bf16_f32 v79, v67, v71
    buffer_store_dwordx2 v[72:73], v7, s[24:27], 0 offen
    buffer_store_dwordx2 v[74:75], v7, s[24:27], 0 offen offset:2560
    buffer_store_dwordx2 v[76:77], v8, s[24:27], 0 offen
    buffer_store_dwordx2 v[78:79], v8, s[24:27], 0 offen offset:2560
    s_cmp_ge_u32 s46, 8
    s_cbranch_scc1 L_io_done
    s_add_u32 s46, s46, 8
    s_setprio 1
    s_branch L_ejob
L_io_done:
    s_endpgm
L_mfma_m:
    s_setprio 3
    ds_read_b128 v[28:31], v1 offset:1536
    ds_read_b128 v[36:39], v1 offset:2048
    ds_read_b128 v[40:43], v1 offset:2560
    ds_read_b128 v[44:47], v1 offset:3072
    ds_read_b128 v[48:51], v1 offset:3584
    s_mov_b64 exec, 1
L_xwait_4:
    ds_read_b64 v[120:121], v4 offset:0
    s_waitcnt lgkmcnt(0)
    v_and_b32 v120, v120, v121
    s_nop 0
    v_readfirstlane_b32 s7, v120
    s_bitcmp1_b32 s7, 2
    s_cbranch_scc1 L_xwait_4_done
    s_sleep 1
    s_branch L_xwait_4
L_xwait_4_done:
    s_mov_b64 exec, -1
    ds_read_b64 v[24:25], v2 offset:3072
    ds_read_b64 v[26:27], v2 offset:3080
    ds_read_b64 v[32:33], v2 offset:3584
    ds_read_b64 v[34:35], v2 offset:3592
    s_waitcnt lgkmcnt(2)
    v_mfma_f32_16x16x32_bf16 v[8:11], v[28:31], v[24:27], v[8:11]
    ds_read_b64 v[52:53], v2 offset:3136
    ds_read_b64 v[54:55], v2 offset:3144
    s_waitcnt lgkmcnt(2)
    v_mfma_f32_16x16x32_bf16 v[8:11], v[36:39], v[32:35], v[8:11]
    ds_read_b128 v[56:59], v1 offset:1600
    v_mfma_f32_16x16x32_bf16 v[12:15], v[36:39], v[24:27], v[12:15]
    ds_read_b64 v[60:61], v2 offset:3648
    v_mfma_f32_16x16x32_bf16 v[12:15], v[40:43], v[32:35], v[12:15]
    ds_read_b64 v[62:63], v2 offset:3656
    v_mfma_f32_16x16x32_bf16 v[16:19], v[40:43], v[24:27], v[16:19]
    ds_read_b128 v[64:67], v1 offset:2112
    v_mfma_f32_16x16x32_bf16 v[16:19], v[44:47], v[32:35], v[16:19]
    ds_read_b128 v[68:71], v1 offset:2624
    v_mfma_f32_16x16x32_bf16 v[20:23], v[44:47], v[24:27], v[20:23]
    ds_read_b128 v[72:75], v1 offset:3136
    v_mfma_f32_16x16x32_bf16 v[20:23], v[48:51], v[32:35], v[20:23]
    ds_read_b128 v[76:79], v1 offset:3648
    s_waitcnt lgkmcnt(6)
    v_mfma_f32_16x16x32_bf16 v[8:11], v[56:59], v[52:55], v[8:11]
    ds_read_b64 v[24:25], v2 offset:3200
    ds_read_b64 v[26:27], v2 offset:3208
    s_waitcnt lgkmcnt(5)
    v_mfma_f32_16x16x32_bf16 v[8:11], v[64:67], v[60:63], v[8:11]
    ds_read_b128 v[28:31], v1 offset:1664
    v_mfma_f32_16x16x32_bf16 v[12:15], v[64:67], v[52:55], v[12:15]
    ds_read_b64 v[32:33], v2 offset:3712
    s_waitcnt lgkmcnt(6)
    v_mfma_f32_16x16x32_bf16 v[12:15], v[68:71], v[60:63], v[12:15]
    ds_read_b64 v[34:35], v2 offset:3720
    v_mfma_f32_16x16x32_bf16 v[16:19], v[68:71], v[52:55], v[16:19]
    ds_read_b128 v[36:39], v1 offset:2176
    s_waitcnt lgkmcnt(7)
    v_mfma_f32_16x16x32_bf16 v[16:19], v[72:75], v[60:63], v[16:19]
    ds_read_b128 v[40:43], v1 offset:2688
    v_mfma_f32_16x16x32_bf16 v[20:23], v[72:75], v[52:55], v[20:23]
    ds_read_b128 v[44:47], v1 offset:3200
    s_waitcnt lgkmcnt(8)
    v_mfma_f32_16x16x32_bf16 v[20:23], v[76:79], v[60:63], v[20:23]
    ds_read_b128 v[48:51], v1 offset:3712
    s_waitcnt lgkmcnt(6)
    v_mfma_f32_16x16x32_bf16 v[8:11], v[28:31], v[24:27], v[8:11]
    ds_read_b64 v[52:53], v2 offset:3264
    ds_read_b64 v[54:55], v2 offset:3272
    s_waitcnt lgkmcnt(5)
    v_mfma_f32_16x16x32_bf16 v[8:11], v[36:39], v[32:35], v[8:11]
    ds_read_b128 v[56:59], v1 offset:1728
    v_mfma_f32_16x16x32_bf16 v[12:15], v[36:39], v[24:27], v[12:15]
    ds_read_b64 v[60:61], v2 offset:3776
    s_waitcnt lgkmcnt(6)
    v_mfma_f32_16x16x32_bf16 v[12:15], v[40:43], v[32:35], v[12:15]
    ds_read_b64 v[62:63], v2 offset:3784
    v_mfma_f32_16x16x32_bf16 v[16:19], v[40:43], v[24:27], v[16:19]
    ds_read_b128 v[64:67], v1 offset:2240
    s_waitcnt lgkmcnt(7)
    v_mfma_f32_16x16x32_bf16 v[16:19], v[44:47], v[32:35], v[16:19]
    ds_read_b128 v[68:71], v1 offset:2752
    v_mfma_f32_16x16x32_bf16 v[20:23], v[44:47], v[24:27], v[20:23]
    ds_read_b128 v[72:75], v1 offset:3264
    s_waitcnt lgkmcnt(8)
    v_mfma_f32_16x16x32_bf16 v[20:23], v[48:51], v[32:35], v[20:23]
    ds_read_b128 v[76:79], v1 offset:3776
    s_waitcnt lgkmcnt(6)
    v_mfma_f32_16x16x32_bf16 v[8:11], v[56:59], v[52:55], v[8:11]
    ds_read_b64 v[24:25], v2 offset:3328
    ds_read_b64 v[26:27], v2 offset:3336
    s_waitcnt lgkmcnt(5)
    v_mfma_f32_16x16x32_bf16 v[8:11], v[64:67], v[60:63], v[8:11]
    ds_read_b128 v[28:31], v1 offset:1792
    v_mfma_f32_16x16x32_bf16 v[12:15], v[64:67], v[52:55], v[12:15]
    ds_read_b64 v[32:33], v2 offset:3840
    s_waitcnt lgkmcnt(6)
    v_mfma_f32_16x16x32_bf16 v[12:15], v[68:71], v[60:63], v[12:15]
    ds_read_b64 v[34:35], v2 offset:3848
    v_mfma_f32_16x16x32_bf16 v[16:19], v[68:71], v[52:55], v[16:19]
    ds_read_b128 v[36:39], v1 offset:2304
    s_waitcnt lgkmcnt(7)
    v_mfma_f32_16x16x32_bf16 v[16:19], v[72:75], v[60:63], v[16:19]
    ds_read_b128 v[40:43], v1 offset:2816
    v_mfma_f32_16x16x32_bf16 v[20:23], v[72:75], v[52:55], v[20:23]
    ds_read_b128 v[44:47], v1 offset:3328
    s_waitcnt lgkmcnt(8)
    v_mfma_f32_16x16x32_bf16 v[20:23], v[76:79], v[60:63], v[20:23]
    ds_read_b128 v[48:51], v1 offset:3840
    s_waitcnt lgkmcnt(6)
    v_mfma_f32_16x16x32_bf16 v[8:11], v[28:31], v[24:27], v[8:11]
    ds_read_b64 v[52:53], v2 offset:3392
    ds_read_b64 v[54:55], v2 offset:3400
    s_waitcnt lgkmcnt(5)
    v_mfma_f32_16x16x32_bf16 v[8:11], v[36:39], v[32:35], v[8:11]
    ds_read_b128 v[56:59], v1 offset:1856
    v_mfma_f32_16x16x32_bf16 v[12:15], v[36:39], v[24:27], v[12:15]
    ds_read_b64 v[60:61], v2 offset:3904
    s_waitcnt lgkmcnt(6)
    v_mfma_f32_16x16x32_bf16 v[12:15], v[40:43], v[32:35], v[12:15]
    ds_read_b64 v[62:63], v2 offset:3912
    v_mfma_f32_16x16x32_bf16 v[16:19], v[40:43], v[24:27], v[16:19]
    ds_read_b128 v[64:67], v1 offset:2368
    s_waitcnt lgkmcnt(7)
    v_mfma_f32_16x16x32_bf16 v[16:19], v[44:47], v[32:35], v[16:19]
    ds_read_b128 v[68:71], v1 offset:2880
    v_mfma_f32_16x16x32_bf16 v[20:23], v[44:47], v[24:27], v[20:23]
    ds_read_b128 v[72:75], v1 offset:3392
    s_waitcnt lgkmcnt(8)
    v_mfma_f32_16x16x32_bf16 v[20:23], v[48:51], v[32:35], v[20:23]
    ds_read_b128 v[76:79], v1 offset:3904
    s_waitcnt lgkmcnt(6)
    v_mfma_f32_16x16x32_bf16 v[8:11], v[56:59], v[52:55], v[8:11]
    ds_read_b64 v[24:25], v2 offset:3456
    ds_read_b64 v[26:27], v2 offset:3464
    s_waitcnt lgkmcnt(5)
    v_mfma_f32_16x16x32_bf16 v[8:11], v[64:67], v[60:63], v[8:11]
    ds_read_b128 v[28:31], v1 offset:1920
    v_mfma_f32_16x16x32_bf16 v[12:15], v[64:67], v[52:55], v[12:15]
    ds_read_b64 v[32:33], v2 offset:3968
    s_waitcnt lgkmcnt(6)
    v_mfma_f32_16x16x32_bf16 v[12:15], v[68:71], v[60:63], v[12:15]
    ds_read_b64 v[34:35], v2 offset:3976
    v_mfma_f32_16x16x32_bf16 v[16:19], v[68:71], v[52:55], v[16:19]
    ds_read_b128 v[36:39], v1 offset:2432
    s_waitcnt lgkmcnt(7)
    v_mfma_f32_16x16x32_bf16 v[16:19], v[72:75], v[60:63], v[16:19]
    ds_read_b128 v[40:43], v1 offset:2944
    v_mfma_f32_16x16x32_bf16 v[20:23], v[72:75], v[52:55], v[20:23]
    ds_read_b128 v[44:47], v1 offset:3456
    s_waitcnt lgkmcnt(8)
    v_mfma_f32_16x16x32_bf16 v[20:23], v[76:79], v[60:63], v[20:23]
    ds_read_b128 v[48:51], v1 offset:3968
    s_waitcnt lgkmcnt(6)
    v_mfma_f32_16x16x32_bf16 v[8:11], v[28:31], v[24:27], v[8:11]
    ds_read_b64 v[52:53], v2 offset:3520
    ds_read_b64 v[54:55], v2 offset:3528
    s_waitcnt lgkmcnt(5)
    v_mfma_f32_16x16x32_bf16 v[8:11], v[36:39], v[32:35], v[8:11]
    ds_read_b128 v[56:59], v1 offset:1984
    v_mfma_f32_16x16x32_bf16 v[12:15], v[36:39], v[24:27], v[12:15]
    ds_read_b64 v[60:61], v2 offset:4032
    s_waitcnt lgkmcnt(6)
    v_mfma_f32_16x16x32_bf16 v[12:15], v[40:43], v[32:35], v[12:15]
    ds_read_b64 v[62:63], v2 offset:4040
    v_mfma_f32_16x16x32_bf16 v[16:19], v[40:43], v[24:27], v[16:19]
    ds_read_b128 v[64:67], v1 offset:2496
    s_waitcnt lgkmcnt(7)
    v_mfma_f32_16x16x32_bf16 v[16:19], v[44:47], v[32:35], v[16:19]
    ds_read_b128 v[68:71], v1 offset:3008
    v_mfma_f32_16x16x32_bf16 v[20:23], v[44:47], v[24:27], v[20:23]
    ds_read_b128 v[72:75], v1 offset:3520
    s_waitcnt lgkmcnt(8)
    v_mfma_f32_16x16x32_bf16 v[20:23], v[48:51], v[32:35], v[20:23]
    ds_read_b128 v[76:79], v1 offset:4032
    s_waitcnt lgkmcnt(6)
    v_mfma_f32_16x16x32_bf16 v[8:11], v[56:59], v[52:55], v[8:11]
    s_waitcnt lgkmcnt(3)
    v_mfma_f32_16x16x32_bf16 v[8:11], v[64:67], v[60:63], v[8:11]
    v_mfma_f32_16x16x32_bf16 v[12:15], v[64:67], v[52:55], v[12:15]
    s_waitcnt lgkmcnt(2)
    v_mfma_f32_16x16x32_bf16 v[12:15], v[68:71], v[60:63], v[12:15]
    v_mfma_f32_16x16x32_bf16 v[16:19], v[68:71], v[52:55], v[16:19]
    s_waitcnt lgkmcnt(1)
    v_mfma_f32_16x16x32_bf16 v[16:19], v[72:75], v[60:63], v[16:19]
    v_mfma_f32_16x16x32_bf16 v[20:23], v[72:75], v[52:55], v[20:23]
    s_waitcnt lgkmcnt(0)
    v_mfma_f32_16x16x32_bf16 v[20:23], v[76:79], v[60:63], v[20:23]
    s_setprio 2
    ds_read_b128 v[28:31], v1 offset:512
    ds_read_b128 v[36:39], v1 offset:1024
    ds_read_b128 v[40:43], v1 offset:1536
    ds_read_b128 v[44:47], v1 offset:2048
    ds_read_b128 v[48:51], v1 offset:2560
    s_mov_b64 exec, 1
L_xwait_5:
    ds_read_b64 v[120:121], v4 offset:8
    s_waitcnt lgkmcnt(0)
    v_and_b32 v120, v120, v121
    s_nop 0
    v_readfirstlane_b32 s7, v120
    s_bitcmp1_b32 s7, 2
    s_cbranch_scc1 L_xwait_5_done
    s_sleep 1
    s_branch L_xwait_5
L_xwait_5_done:
    s_mov_b64 exec, -1
    ds_read_b64 v[24:25], v2 offset:2048
    ds_read_b64 v[26:27], v2 offset:2056
    ds_read_b64 v[32:33], v2 offset:2560
    ds_read_b64 v[34:35], v2 offset:2568
    s_waitcnt lgkmcnt(2)
    v_mfma_f32_16x16x32_bf16 v[8:11], v[28:31], v[24:27], v[8:11]
    ds_read_b64 v[52:53], v2 offset:2112
    ds_read_b64 v[54:55], v2 offset:2120
    s_waitcnt lgkmcnt(2)
    v_mfma_f32_16x16x32_bf16 v[8:11], v[36:39], v[32:35], v[8:11]
    ds_read_b128 v[56:59], v1 offset:576
    v_mfma_f32_16x16x32_bf16 v[12:15], v[36:39], v[24:27], v[12:15]
    ds_read_b64 v[60:61], v2 offset:2624
    v_mfma_f32_16x16x32_bf16 v[12:15], v[40:43], v[32:35], v[12:15]
    ds_read_b64 v[62:63], v2 offset:2632
    v_mfma_f32_16x16x32_bf16 v[16:19], v[40:43], v[24:27], v[16:19]
    ds_read_b128 v[64:67], v1 offset:1088
    v_mfma_f32_16x16x32_bf16 v[16:19], v[44:47], v[32:35], v[16:19]
    ds_read_b128 v[68:71], v1 offset:1600
    v_mfma_f32_16x16x32_bf16 v[20:23], v[44:47], v[24:27], v[20:23]
    ds_read_b128 v[72:75], v1 offset:2112
    v_mfma_f32_16x16x32_bf16 v[20:23], v[48:51], v[32:35], v[20:23]
    ds_read_b128 v[76:79], v1 offset:2624
    s_waitcnt lgkmcnt(6)
    v_mfma_f32_16x16x32_bf16 v[8:11], v[56:59], v[52:55], v[8:11]
    ds_read_b64 v[24:25], v2 offset:2176
    ds_read_b64 v[26:27], v2 offset:2184
    s_waitcnt lgkmcnt(5)
    v_mfma_f32_16x16x32_bf16 v[8:11], v[64:67], v[60:63], v[8:11]
    ds_read_b128 v[28:31], v1 offset:640
    v_mfma_f32_16x16x32_bf16 v[12:15], v[64:67], v[52:55], v[12:15]
    ds_read_b64 v[32:33], v2 offset:2688
    s_waitcnt lgkmcnt(6)
    v_mfma_f32_16x16x32_bf16 v[12:15], v[68:71], v[60:63], v[12:15]
    ds_read_b64 v[34:35], v2 offset:2696
    v_mfma_f32_16x16x32_bf16 v[16:19], v[68:71], v[52:55], v[16:19]
    ds_read_b128 v[36:39], v1 offset:1152
    s_waitcnt lgkmcnt(7)
    v_mfma_f32_16x16x32_bf16 v[16:19], v[72:75], v[60:63], v[16:19]
    ds_read_b128 v[40:43], v1 offset:1664
    v_mfma_f32_16x16x32_bf16 v[20:23], v[72:75], v[52:55], v[20:23]
    ds_read_b128 v[44:47], v1 offset:2176
    s_waitcnt lgkmcnt(8)
    v_mfma_f32_16x16x32_bf16 v[20:23], v[76:79], v[60:63], v[20:23]
    ds_read_b128 v[48:51], v1 offset:2688
    s_waitcnt lgkmcnt(6)
    v_mfma_f32_16x16x32_bf16 v[8:11], v[28:31], v[24:27], v[8:11]
    ds_read_b64 v[52:53], v2 offset:2240
    ds_read_b64 v[54:55], v2 offset:2248
    s_waitcnt lgkmcnt(5)
    v_mfma_f32_16x16x32_bf16 v[8:11], v[36:39], v[32:35], v[8:11]
    ds_read_b128 v[56:59], v1 offset:704
    v_mfma_f32_16x16x32_bf16 v[12:15], v[36:39], v[24:27], v[12:15]
    ds_read_b64 v[60:61], v2 offset:2752
    s_waitcnt lgkmcnt(6)
    v_mfma_f32_16x16x32_bf16 v[12:15], v[40:43], v[32:35], v[12:15]
    ds_read_b64 v[62:63], v2 offset:2760
    v_mfma_f32_16x16x32_bf16 v[16:19], v[40:43], v[24:27], v[16:19]
    ds_read_b128 v[64:67], v1 offset:1216
    s_waitcnt lgkmcnt(7)
    v_mfma_f32_16x16x32_bf16 v[16:19], v[44:47], v[32:35], v[16:19]
    ds_read_b128 v[68:71], v1 offset:1728
    v_mfma_f32_16x16x32_bf16 v[20:23], v[44:47], v[24:27], v[20:23]
    ds_read_b128 v[72:75], v1 offset:2240
    s_waitcnt lgkmcnt(8)
    v_mfma_f32_16x16x32_bf16 v[20:23], v[48:51], v[32:35], v[20:23]
    ds_read_b128 v[76:79], v1 offset:2752
    s_waitcnt lgkmcnt(6)
    v_mfma_f32_16x16x32_bf16 v[8:11], v[56:59], v[52:55], v[8:11]
    ds_read_b64 v[24:25], v2 offset:2304
    ds_read_b64 v[26:27], v2 offset:2312
    s_waitcnt lgkmcnt(5)
    v_mfma_f32_16x16x32_bf16 v[8:11], v[64:67], v[60:63], v[8:11]
    ds_read_b128 v[28:31], v1 offset:768
    v_mfma_f32_16x16x32_bf16 v[12:15], v[64:67], v[52:55], v[12:15]
    ds_read_b64 v[32:33], v2 offset:2816
    s_waitcnt lgkmcnt(6)
    v_mfma_f32_16x16x32_bf16 v[12:15], v[68:71], v[60:63], v[12:15]
    ds_read_b64 v[34:35], v2 offset:2824
    v_mfma_f32_16x16x32_bf16 v[16:19], v[68:71], v[52:55], v[16:19]
    ds_read_b128 v[36:39], v1 offset:1280
    s_waitcnt lgkmcnt(7)
    v_mfma_f32_16x16x32_bf16 v[16:19], v[72:75], v[60:63], v[16:19]
    ds_read_b128 v[40:43], v1 offset:1792
    v_mfma_f32_16x16x32_bf16 v[20:23], v[72:75], v[52:55], v[20:23]
    ds_read_b128 v[44:47], v1 offset:2304
    s_waitcnt lgkmcnt(8)
    v_mfma_f32_16x16x32_bf16 v[20:23], v[76:79], v[60:63], v[20:23]
    ds_read_b128 v[48:51], v1 offset:2816
    s_waitcnt lgkmcnt(6)
    v_mfma_f32_16x16x32_bf16 v[8:11], v[28:31], v[24:27], v[8:11]
    ds_read_b64 v[52:53], v2 offset:2368
    ds_read_b64 v[54:55], v2 offset:2376
    s_waitcnt lgkmcnt(5)
    v_mfma_f32_16x16x32_bf16 v[8:11], v[36:39], v[32:35], v[8:11]
    ds_read_b128 v[56:59], v1 offset:832
    v_mfma_f32_16x16x32_bf16 v[12:15], v[36:39], v[24:27], v[12:15]
    ds_read_b64 v[60:61], v2 offset:2880
    s_waitcnt lgkmcnt(6)
    v_mfma_f32_16x16x32_bf16 v[12:15], v[40:43], v[32:35], v[12:15]
    ds_read_b64 v[62:63], v2 offset:2888
    v_mfma_f32_16x16x32_bf16 v[16:19], v[40:43], v[24:27], v[16:19]
    ds_read_b128 v[64:67], v1 offset:1344
    s_waitcnt lgkmcnt(7)
    v_mfma_f32_16x16x32_bf16 v[16:19], v[44:47], v[32:35], v[16:19]
    ds_read_b128 v[68:71], v1 offset:1856
    v_mfma_f32_16x16x32_bf16 v[20:23], v[44:47], v[24:27], v[20:23]
    ds_read_b128 v[72:75], v1 offset:2368
    s_waitcnt lgkmcnt(8)
    v_mfma_f32_16x16x32_bf16 v[20:23], v[48:51], v[32:35], v[20:23]
    ds_read_b128 v[76:79], v1 offset:2880
    s_waitcnt lgkmcnt(6)
    v_mfma_f32_16x16x32_bf16 v[8:11], v[56:59], v[52:55], v[8:11]
    ds_read_b64 v[24:25], v2 offset:2432
    ds_read_b64 v[26:27], v2 offset:2440
    s_waitcnt lgkmcnt(5)
    v_mfma_f32_16x16x32_bf16 v[8:11], v[64:67], v[60:63], v[8:11]
    ds_read_b128 v[28:31], v1 offset:896
    v_mfma_f32_16x16x32_bf16 v[12:15], v[64:67], v[52:55], v[12:15]
    ds_read_b64 v[32:33], v2 offset:2944
    s_waitcnt lgkmcnt(6)
    v_mfma_f32_16x16x32_bf16 v[12:15], v[68:71], v[60:63], v[12:15]
    ds_read_b64 v[34:35], v2 offset:2952
    v_mfma_f32_16x16x32_bf16 v[16:19], v[68:71], v[52:55], v[16:19]
    ds_read_b128 v[36:39], v1 offset:1408
    s_waitcnt lgkmcnt(7)
    v_mfma_f32_16x16x32_bf16 v[16:19], v[72:75], v[60:63], v[16:19]
    ds_read_b128 v[40:43], v1 offset:1920
    v_mfma_f32_16x16x32_bf16 v[20:23], v[72:75], v[52:55], v[20:23]
    ds_read_b128 v[44:47], v1 offset:2432
    s_waitcnt lgkmcnt(8)
    v_mfma_f32_16x16x32_bf16 v[20:23], v[76:79], v[60:63], v[20:23]
    ds_read_b128 v[48:51], v1 offset:2944
    s_waitcnt lgkmcnt(6)
    v_mfma_f32_16x16x32_bf16 v[8:11], v[28:31], v[24:27], v[8:11]
    ds_read_b64 v[52:53], v2 offset:2496
    ds_read_b64 v[54:55], v2 offset:2504
    s_waitcnt lgkmcnt(5)
    v_mfma_f32_16x16x32_bf16 v[8:11], v[36:39], v[32:35], v[8:11]
    ds_read_b128 v[56:59], v1 offset:960
    v_mfma_f32_16x16x32_bf16 v[12:15], v[36:39], v[24:27], v[12:15]
    ds_read_b64 v[60:61], v2 offset:3008
    s_waitcnt lgkmcnt(6)
    v_mfma_f32_16x16x32_bf16 v[12:15], v[40:43], v[32:35], v[12:15]
    ds_read_b64 v[62:63], v2 offset:3016
    v_mfma_f32_16x16x32_bf16 v[16:19], v[40:43], v[24:27], v[16:19]
    ds_read_b128 v[64:67], v1 offset:1472
    s_waitcnt lgkmcnt(7)
    v_mfma_f32_16x16x32_bf16 v[16:19], v[44:47], v[32:35], v[16:19]
    ds_read_b128 v[68:71], v1 offset:1984
    v_mfma_f32_16x16x32_bf16 v[20:23], v[44:47], v[24:27], v[20:23]
    ds_read_b128 v[72:75], v1 offset:2496
    s_waitcnt lgkmcnt(8)
    v_mfma_f32_16x16x32_bf16 v[20:23], v[48:51], v[32:35], v[20:23]
    ds_read_b128 v[76:79], v1 offset:3008
    s_waitcnt lgkmcnt(6)
    v_mfma_f32_16x16x32_bf16 v[8:11], v[56:59], v[52:55], v[8:11]
    s_waitcnt lgkmcnt(3)
    v_mfma_f32_16x16x32_bf16 v[8:11], v[64:67], v[60:63], v[8:11]
    v_mfma_f32_16x16x32_bf16 v[12:15], v[64:67], v[52:55], v[12:15]
    s_waitcnt lgkmcnt(2)
    v_mfma_f32_16x16x32_bf16 v[12:15], v[68:71], v[60:63], v[12:15]
    v_mfma_f32_16x16x32_bf16 v[16:19], v[68:71], v[52:55], v[16:19]
    s_waitcnt lgkmcnt(1)
    v_mfma_f32_16x16x32_bf16 v[16:19], v[72:75], v[60:63], v[16:19]
    v_mfma_f32_16x16x32_bf16 v[20:23], v[72:75], v[52:55], v[20:23]
    s_waitcnt lgkmcnt(0)
    v_mfma_f32_16x16x32_bf16 v[20:23], v[76:79], v[60:63], v[20:23]
    s_setprio 1
    ds_read_b128 v[28:31], v1 offset:0
    ds_read_b128 v[36:39], v1 offset:512
    ds_read_b128 v[40:43], v1 offset:1024
    ds_read_b128 v[44:47], v1 offset:1536
    s_mov_b64 exec, 1
L_xwait_6:
    ds_read_b64 v[120:121], v4 offset:16
    s_waitcnt lgkmcnt(0)
    v_and_b32 v120, v120, v121
    s_nop 0
    v_readfirstlane_b32 s7, v120
    s_bitcmp1_b32 s7, 2
    s_cbranch_scc1 L_xwait_6_done
    s_sleep 1
    s_branch L_xwait_6
L_xwait_6_done:
    s_mov_b64 exec, -1
    ds_read_b64 v[24:25], v2 offset:1536
    ds_read_b64 v[26:27], v2 offset:1544
    ds_read_b64 v[32:33], v2 offset:1024
    ds_read_b64 v[34:35], v2 offset:1032
    s_waitcnt lgkmcnt(2)
    v_mfma_f32_16x16x32_bf16 v[8:11], v[28:31], v[24:27], v[8:11]
    ds_read_b64 v[48:49], v2 offset:1600
    ds_read_b64 v[50:51], v2 offset:1608
    s_waitcnt lgkmcnt(2)
    v_mfma_f32_16x16x32_bf16 v[12:15], v[28:31], v[32:35], v[12:15]
    ds_read_b128 v[52:55], v1 offset:64
    v_mfma_f32_16x16x32_bf16 v[12:15], v[36:39], v[24:27], v[12:15]
    ds_read_b64 v[56:57], v2 offset:1088
    v_mfma_f32_16x16x32_bf16 v[16:19], v[36:39], v[32:35], v[16:19]
    ds_read_b64 v[58:59], v2 offset:1096
    v_mfma_f32_16x16x32_bf16 v[16:19], v[40:43], v[24:27], v[16:19]
    ds_read_b128 v[60:63], v1 offset:576
    v_mfma_f32_16x16x32_bf16 v[20:23], v[40:43], v[32:35], v[20:23]
    ds_read_b128 v[64:67], v1 offset:1088
    v_mfma_f32_16x16x32_bf16 v[20:23], v[44:47], v[24:27], v[20:23]
    ds_read_b128 v[68:71], v1 offset:1600
    s_waitcnt lgkmcnt(5)
    v_mfma_f32_16x16x32_bf16 v[8:11], v[52:55], v[48:51], v[8:11]
    ds_read_b64 v[24:25], v2 offset:1664
    ds_read_b64 v[26:27], v2 offset:1672
    s_waitcnt lgkmcnt(5)
    v_mfma_f32_16x16x32_bf16 v[12:15], v[52:55], v[56:59], v[12:15]
    ds_read_b128 v[28:31], v1 offset:128
    s_waitcnt lgkmcnt(5)
    v_mfma_f32_16x16x32_bf16 v[12:15], v[60:63], v[48:51], v[12:15]
    ds_read_b64 v[32:33], v2 offset:1152
    v_mfma_f32_16x16x32_bf16 v[16:19], v[60:63], v[56:59], v[16:19]
    ds_read_b64 v[34:35], v2 offset:1160
    s_waitcnt lgkmcnt(6)
    v_mfma_f32_16x16x32_bf16 v[16:19], v[64:67], v[48:51], v[16:19]
    ds_read_b128 v[36:39], v1 offset:640
    v_mfma_f32_16x16x32_bf16 v[20:23], v[64:67], v[56:59], v[20:23]
    ds_read_b128 v[40:43], v1 offset:1152
    s_waitcnt lgkmcnt(7)
    v_mfma_f32_16x16x32_bf16 v[20:23], v[68:71], v[48:51], v[20:23]
    ds_read_b128 v[44:47], v1 offset:1664
    s_waitcnt lgkmcnt(5)
    v_mfma_f32_16x16x32_bf16 v[8:11], v[28:31], v[24:27], v[8:11]
    ds_read_b64 v[48:49], v2 offset:1728
    ds_read_b64 v[50:51], v2 offset:1736
    s_waitcnt lgkmcnt(5)
    v_mfma_f32_16x16x32_bf16 v[12:15], v[28:31], v[32:35], v[12:15]
    ds_read_b128 v[52:55], v1 offset:192
    s_waitcnt lgkmcnt(5)
    v_mfma_f32_16x16x32_bf16 v[12:15], v[36:39], v[24:27], v[12:15]
    ds_read_b64 v[56:57], v2 offset:1216
    v_mfma_f32_16x16x32_bf16 v[16:19], v[36:39], v[32:35], v[16:19]
    ds_read_b64 v[58:59], v2 offset:1224
    s_waitcnt lgkmcnt(6)
    v_mfma_f32_16x16x32_bf16 v[16:19], v[40:43], v[24:27], v[16:19]
    ds_read_b128 v[60:63], v1 offset:704
    v_mfma_f32_16x16x32_bf16 v[20:23], v[40:43], v[32:35], v[20:23]
    ds_read_b128 v[64:67], v1 offset:1216
    s_waitcnt lgkmcnt(7)
    v_mfma_f32_16x16x32_bf16 v[20:23], v[44:47], v[24:27], v[20:23]
    ds_read_b128 v[68:71], v1 offset:1728
    s_waitcnt lgkmcnt(5)
    v_mfma_f32_16x16x32_bf16 v[8:11], v[52:55], v[48:51], v[8:11]
    ds_read_b64 v[24:25], v2 offset:1792
    ds_read_b64 v[26:27], v2 offset:1800
    s_waitcnt lgkmcnt(5)
    v_mfma_f32_16x16x32_bf16 v[12:15], v[52:55], v[56:59], v[12:15]
    ds_read_b128 v[28:31], v1 offset:256
    s_waitcnt lgkmcnt(5)
    v_mfma_f32_16x16x32_bf16 v[12:15], v[60:63], v[48:51], v[12:15]
    ds_read_b64 v[32:33], v2 offset:1280
    v_mfma_f32_16x16x32_bf16 v[16:19], v[60:63], v[56:59], v[16:19]
    ds_read_b64 v[34:35], v2 offset:1288
    s_waitcnt lgkmcnt(6)
    v_mfma_f32_16x16x32_bf16 v[16:19], v[64:67], v[48:51], v[16:19]
    ds_read_b128 v[36:39], v1 offset:768
    v_mfma_f32_16x16x32_bf16 v[20:23], v[64:67], v[56:59], v[20:23]
    ds_read_b128 v[40:43], v1 offset:1280
    s_waitcnt lgkmcnt(7)
    v_mfma_f32_16x16x32_bf16 v[20:23], v[68:71], v[48:51], v[20:23]
    ds_read_b128 v[44:47], v1 offset:1792
    s_waitcnt lgkmcnt(5)
    v_mfma_f32_16x16x32_bf16 v[8:11], v[28:31], v[24:27], v[8:11]
    ds_read_b64 v[48:49], v2 offset:1856
    ds_read_b64 v[50:51], v2 offset:1864
    s_waitcnt lgkmcnt(5)
    v_mfma_f32_16x16x32_bf16 v[12:15], v[28:31], v[32:35], v[12:15]
    ds_read_b128 v[52:55], v1 offset:320
    s_waitcnt lgkmcnt(5)
    v_mfma_f32_16x16x32_bf16 v[12:15], v[36:39], v[24:27], v[12:15]
    ds_read_b64 v[56:57], v2 offset:1344
    v_mfma_f32_16x16x32_bf16 v[16:19], v[36:39], v[32:35], v[16:19]
    ds_read_b64 v[58:59], v2 offset:1352
    s_waitcnt lgkmcnt(6)
    v_mfma_f32_16x16x32_bf16 v[16:19], v[40:43], v[24:27], v[16:19]
    ds_read_b128 v[60:63], v1 offset:832
    v_mfma_f32_16x16x32_bf16 v[20:23], v[40:43], v[32:35], v[20:23]
    ds_read_b128 v[64:67], v1 offset:1344
    s_waitcnt lgkmcnt(7)
    v_mfma_f32_16x16x32_bf16 v[20:23], v[44:47], v[24:27], v[20:23]
    ds_read_b128 v[68:71], v1 offset:1856
    s_waitcnt lgkmcnt(5)
    v_mfma_f32_16x16x32_bf16 v[8:11], v[52:55], v[48:51], v[8:11]
    ds_read_b64 v[24:25], v2 offset:1920
    ds_read_b64 v[26:27], v2 offset:1928
    s_waitcnt lgkmcnt(5)
    v_mfma_f32_16x16x32_bf16 v[12:15], v[52:55], v[56:59], v[12:15]
    ds_read_b128 v[28:31], v1 offset:384
    s_waitcnt lgkmcnt(5)
    v_mfma_f32_16x16x32_bf16 v[12:15], v[60:63], v[48:51], v[12:15]
    ds_read_b64 v[32:33], v2 offset:1408
    v_mfma_f32_16x16x32_bf16 v[16:19], v[60:63], v[56:59], v[16:19]
    ds_read_b64 v[34:35], v2 offset:1416
    s_waitcnt lgkmcnt(6)
    v_mfma_f32_16x16x32_bf16 v[16:19], v[64:67], v[48:51], v[16:19]
    ds_read_b128 v[36:39], v1 offset:896
    v_mfma_f32_16x16x32_bf16 v[20:23], v[64:67], v[56:59], v[20:23]
    ds_read_b128 v[40:43], v1 offset:1408
    s_waitcnt lgkmcnt(7)
    v_mfma_f32_16x16x32_bf16 v[20:23], v[68:71], v[48:51], v[20:23]
    ds_read_b128 v[44:47], v1 offset:1920
    s_waitcnt lgkmcnt(5)
    v_mfma_f32_16x16x32_bf16 v[8:11], v[28:31], v[24:27], v[8:11]
    ds_read_b64 v[48:49], v2 offset:1984
    ds_read_b64 v[50:51], v2 offset:1992
    s_waitcnt lgkmcnt(5)
    v_mfma_f32_16x16x32_bf16 v[12:15], v[28:31], v[32:35], v[12:15]
    ds_read_b128 v[52:55], v1 offset:448
    s_waitcnt lgkmcnt(5)
    v_mfma_f32_16x16x32_bf16 v[12:15], v[36:39], v[24:27], v[12:15]
    ds_read_b64 v[56:57], v2 offset:1472
    v_mfma_f32_16x16x32_bf16 v[16:19], v[36:39], v[32:35], v[16:19]
    ds_read_b64 v[58:59], v2 offset:1480
    s_waitcnt lgkmcnt(6)
    v_mfma_f32_16x16x32_bf16 v[16:19], v[40:43], v[24:27], v[16:19]
    ds_read_b128 v[60:63], v1 offset:960
    v_mfma_f32_16x16x32_bf16 v[20:23], v[40:43], v[32:35], v[20:23]
    ds_read_b128 v[64:67], v1 offset:1472
    s_waitcnt lgkmcnt(7)
    v_mfma_f32_16x16x32_bf16 v[20:23], v[44:47], v[24:27], v[20:23]
    ds_read_b128 v[68:71], v1 offset:1984
    s_waitcnt lgkmcnt(5)
    v_mfma_f32_16x16x32_bf16 v[8:11], v[52:55], v[48:51], v[8:11]
    s_waitcnt lgkmcnt(3)
    v_mfma_f32_16x16x32_bf16 v[12:15], v[52:55], v[56:59], v[12:15]
    s_waitcnt lgkmcnt(2)
    v_mfma_f32_16x16x32_bf16 v[12:15], v[60:63], v[48:51], v[12:15]
    v_mfma_f32_16x16x32_bf16 v[16:19], v[60:63], v[56:59], v[16:19]
    s_waitcnt lgkmcnt(1)
    v_mfma_f32_16x16x32_bf16 v[16:19], v[64:67], v[48:51], v[16:19]
    v_mfma_f32_16x16x32_bf16 v[20:23], v[64:67], v[56:59], v[20:23]
    s_waitcnt lgkmcnt(0)
    v_mfma_f32_16x16x32_bf16 v[20:23], v[68:71], v[48:51], v[20:23]
    s_nop 7
    ds_write_b64 v3, v[8:9] offset:1024
    ds_write_b64 v3, v[10:11] offset:1152
    ds_write_b64 v3, v[12:13] offset:5248
    ds_write_b64 v3, v[14:15] offset:5376
    s_waitcnt lgkmcnt(0)
    s_mov_b64 exec, 1
    ds_add_u32 v4, v5 offset:40
    s_mov_b64 exec, -1
    s_setprio 0
    ds_read_b128 v[24:27], v1 offset:0
    ds_read_b128 v[28:31], v1 offset:512
    ds_read_b128 v[32:35], v1 offset:64
    ds_read_b128 v[36:39], v1 offset:576
    ds_read_b128 v[40:43], v1 offset:128
    ds_read_b128 v[44:47], v1 offset:640
    ds_read_b128 v[48:51], v1 offset:192
    ds_read_b128 v[52:55], v1 offset:704
    ds_read_b128 v[56:59], v1 offset:256
    ds_read_b128 v[60:63], v1 offset:768
    ds_read_b128 v[64:67], v1 offset:320
    ds_read_b128 v[68:71], v1 offset:832
    ds_read_b128 v[72:75], v1 offset:384
    ds_read_b128 v[76:79], v1 offset:896
    ds_read_b128 v[80:83], v1 offset:448
    ds_read_b128 v[84:87], v1 offset:960
    s_mov_b64 exec, 1
L_xwait_7:
    ds_read_b64 v[120:121], v4 offset:24
    s_waitcnt lgkmcnt(0)
    v_and_b32 v120, v120, v121
    s_nop 0
    v_readfirstlane_b32 s7, v120
    s_bitcmp1_b32 s7, 2
    s_cbranch_scc1 L_xwait_7_done
    s_sleep 1
    s_branch L_xwait_7
L_xwait_7_done:
    s_mov_b64 exec, -1
    ds_read_b64 v[88:89], v2 offset:512
    ds_read_b64 v[90:91], v2 offset:520
    ds_read_b64 v[92:93], v2 offset:0
    ds_read_b64 v[94:95], v2 offset:8
    ds_read_b64 v[96:97], v2 offset:576
    ds_read_b64 v[98:99], v2 offset:584
    ds_read_b64 v[100:101], v2 offset:64
    ds_read_b64 v[102:103], v2 offset:72
    ds_read_b64 v[104:105], v2 offset:640
    ds_read_b64 v[106:107], v2 offset:648
    ds_read_b64 v[108:109], v2 offset:128
    ds_read_b64 v[110:111], v2 offset:136
    s_waitcnt lgkmcnt(10)
    v_mfma_f32_16x16x32_bf16 v[16:19], v[24:27], v[88:91], v[16:19]
    ds_read_b64 v[112:113], v2 offset:704
    ds_read_b64 v[114:115], v2 offset:712
    s_waitcnt lgkmcnt(10)
    v_mfma_f32_16x16x32_bf16 v[20:23], v[24:27], v[92:95], v[20:23]
    ds_read_b64 v[116:117], v2 offset:192
    v_mfma_f32_16x16x32_bf16 v[20:23], v[28:31], v[88:91], v[20:23]
    ds_read_b64 v[118:119], v2 offset:200
    s_waitcnt lgkmcnt(10)
    v_mfma_f32_16x16x32_bf16 v[16:19], v[32:35], v[96:99], v[16:19]
    ds_read_b64 v[88:89], v2 offset:768
    ds_read_b64 v[90:91], v2 offset:776
    s_waitcnt lgkmcnt(10)
    v_mfma_f32_16x16x32_bf16 v[20:23], v[32:35], v[100:103], v[20:23]
    ds_read_b64 v[92:93], v2 offset:256
    v_mfma_f32_16x16x32_bf16 v[20:23], v[36:39], v[96:99], v[20:23]
    ds_read_b64 v[94:95], v2 offset:264
    s_waitcnt lgkmcnt(10)
    v_mfma_f32_16x16x32_bf16 v[16:19], v[40:43], v[104:107], v[16:19]
    ds_read_b64 v[96:97], v2 offset:832
    ds_read_b64 v[98:99], v2 offset:840
    s_waitcnt lgkmcnt(10)
    v_mfma_f32_16x16x32_bf16 v[20:23], v[40:43], v[108:111], v[20:23]
    ds_read_b64 v[100:101], v2 offset:320
    v_mfma_f32_16x16x32_bf16 v[20:23], v[44:47], v[104:107], v[20:23]
    ds_read_b64 v[102:103], v2 offset:328
    s_waitcnt lgkmcnt(10)
    v_mfma_f32_16x16x32_bf16 v[16:19], v[48:51], v[112:115], v[16:19]
    ds_read_b64 v[104:105], v2 offset:896
    ds_read_b64 v[106:107], v2 offset:904
    s_waitcnt lgkmcnt(10)
    v_mfma_f32_16x16x32_bf16 v[20:23], v[48:51], v[116:119], v[20:23]
    ds_read_b64 v[108:109], v2 offset:384
    v_mfma_f32_16x16x32_bf16 v[20:23], v[52:55], v[112:115], v[20:23]
    ds_read_b64 v[110:111], v2 offset:392
    s_waitcnt lgkmcnt(10)
    v_mfma_f32_16x16x32_bf16 v[16:19], v[56:59], v[88:91], v[16:19]
    ds_read_b64 v[112:113], v2 offset:960
    ds_read_b64 v[114:115], v2 offset:968
    s_waitcnt lgkmcnt(10)
    v_mfma_f32_16x16x32_bf16 v[20:23], v[56:59], v[92:95], v[20:23]
    ds_read_b64 v[116:117], v2 offset:448
    v_mfma_f32_16x16x32_bf16 v[20:23], v[60:63], v[88:91], v[20:23]
    ds_read_b64 v[118:119], v2 offset:456
    s_waitcnt lgkmcnt(10)
    v_mfma_f32_16x16x32_bf16 v[16:19], v[64:67], v[96:99], v[16:19]
    s_waitcnt lgkmcnt(8)
    v_mfma_f32_16x16x32_bf16 v[20:23], v[64:67], v[100:103], v[20:23]
    v_mfma_f32_16x16x32_bf16 v[20:23], v[68:71], v[96:99], v[20:23]
    s_waitcnt lgkmcnt(6)
    v_mfma_f32_16x16x32_bf16 v[16:19], v[72:75], v[104:107], v[16:19]
    s_waitcnt lgkmcnt(4)
    v_mfma_f32_16x16x32_bf16 v[20:23], v[72:75], v[108:111], v[20:23]
    v_mfma_f32_16x16x32_bf16 v[20:23], v[76:79], v[104:107], v[20:23]
    s_waitcnt lgkmcnt(2)
    v_mfma_f32_16x16x32_bf16 v[16:19], v[80:83], v[112:115], v[16:19]
    s_waitcnt lgkmcnt(0)
    v_mfma_f32_16x16x32_bf16 v[20:23], v[80:83], v[116:119], v[20:23]
    v_mfma_f32_16x16x32_bf16 v[20:23], v[84:87], v[112:115], v[20:23]
    s_nop 7
    ds_write_b64 v3, v[16:17] offset:0
    ds_write_b64 v3, v[18:19] offset:128
    ds_write_b64 v3, v[20:21] offset:4224
    ds_write_b64 v3, v[22:23] offset:4352
    s_waitcnt lgkmcnt(0)
    s_mov_b64 exec, 1
    ds_add_u32 v4, v5 offset:44
    s_mov_b64 exec, -1
    s_endpgm
L_mfma_h:
    s_setprio 1
    ds_read_b128 v[44:47], v1 offset:0
    ds_read_b128 v[52:55], v1 offset:512
    ds_read_b128 v[56:59], v1 offset:1024
    ds_read_b128 v[60:63], v1 offset:1536
    s_mov_b64 exec, 1
L_xwait_8:
    ds_read_b64 v[120:121], v4 offset:0
    s_waitcnt lgkmcnt(0)
    v_and_b32 v120, v120, v121
    s_nop 0
    v_readfirstlane_b32 s7, v120
    s_bitcmp1_b32 s7, 2
    s_cbranch_scc1 L_xwait_8_done
    s_sleep 1
    s_branch L_xwait_8
L_xwait_8_done:
    s_mov_b64 exec, -1
    ds_read_b64 v[40:41], v2 offset:1536
    ds_read_b64 v[42:43], v2 offset:1544
    ds_read_b64 v[48:49], v2 offset:1024
    ds_read_b64 v[50:51], v2 offset:1032
    s_waitcnt lgkmcnt(2)
    v_mfma_f32_16x16x32_bf16 v[8:11], v[44:47], v[40:43], v[8:11]
    ds_read_b64 v[64:65], v2 offset:5920
    ds_read_b64 v[66:67], v2 offset:5928
    s_waitcnt lgkmcnt(2)
    v_mfma_f32_16x16x32_bf16 v[12:15], v[44:47], v[48:51], v[12:15]
    ds_read_b128 v[68:71], v1 offset:5056
    v_mfma_f32_16x16x32_bf16 v[12:15], v[52:55], v[40:43], v[12:15]
    ds_read_b64 v[72:73], v2 offset:5408
    v_mfma_f32_16x16x32_bf16 v[16:19], v[52:55], v[48:51], v[16:19]
    ds_read_b64 v[74:75], v2 offset:5416
    v_mfma_f32_16x16x32_bf16 v[16:19], v[56:59], v[40:43], v[16:19]
    ds_read_b128 v[76:79], v1 offset:5568
    v_mfma_f32_16x16x32_bf16 v[20:23], v[56:59], v[48:51], v[20:23]
    ds_read_b128 v[80:83], v1 offset:6080
    v_mfma_f32_16x16x32_bf16 v[20:23], v[60:63], v[40:43], v[20:23]
    ds_read_b128 v[84:87], v1 offset:6592
    s_waitcnt lgkmcnt(5)
    v_mfma_f32_16x16x32_bf16 v[24:27], v[68:71], v[64:67], v[24:27]
    ds_read_b64 v[40:41], v2 offset:1600
    ds_read_b64 v[42:43], v2 offset:1608
    s_waitcnt lgkmcnt(5)
    v_mfma_f32_16x16x32_bf16 v[28:31], v[68:71], v[72:75], v[28:31]
    ds_read_b128 v[44:47], v1 offset:64
    s_waitcnt lgkmcnt(5)
    v_mfma_f32_16x16x32_bf16 v[28:31], v[76:79], v[64:67], v[28:31]
    ds_read_b64 v[48:49], v2 offset:1088
    v_mfma_f32_16x16x32_bf16 v[32:35], v[76:79], v[72:75], v[32:35]
    ds_read_b64 v[50:51], v2 offset:1096
    s_waitcnt lgkmcnt(6)
    v_mfma_f32_16x16x32_bf16 v[32:35], v[80:83], v[64:67], v[32:35]
    ds_read_b128 v[52:55], v1 offset:576
    v_mfma_f32_16x16x32_bf16 v[36:39], v[80:83], v[72:75], v[36:39]
    ds_read_b128 v[56:59], v1 offset:1088
    s_waitcnt lgkmcnt(7)
    v_mfma_f32_16x16x32_bf16 v[36:39], v[84:87], v[64:67], v[36:39]
    ds_read_b128 v[60:63], v1 offset:1600
    s_waitcnt lgkmcnt(5)
    v_mfma_f32_16x16x32_bf16 v[8:11], v[44:47], v[40:43], v[8:11]
    ds_read_b64 v[64:65], v2 offset:5984
    ds_read_b64 v[66:67], v2 offset:5992
    s_waitcnt lgkmcnt(5)
    v_mfma_f32_16x16x32_bf16 v[12:15], v[44:47], v[48:51], v[12:15]
    ds_read_b128 v[68:71], v1 offset:5120
    s_waitcnt lgkmcnt(5)
    v_mfma_f32_16x16x32_bf16 v[12:15], v[52:55], v[40:43], v[12:15]
    ds_read_b64 v[72:73], v2 offset:5472
    v_mfma_f32_16x16x32_bf16 v[16:19], v[52:55], v[48:51], v[16:19]
    ds_read_b64 v[74:75], v2 offset:5480
    s_waitcnt lgkmcnt(6)
    v_mfma_f32_16x16x32_bf16 v[16:19], v[56:59], v[40:43], v[16:19]
    ds_read_b128 v[76:79], v1 offset:5632
    v_mfma_f32_16x16x32_bf16 v[20:23], v[56:59], v[48:51], v[20:23]
    ds_read_b128 v[80:83], v1 offset:6144
    s_waitcnt lgkmcnt(7)
    v_mfma_f32_16x16x32_bf16 v[20:23], v[60:63], v[40:43], v[20:23]
    ds_read_b128 v[84:87], v1 offset:6656
    s_waitcnt lgkmcnt(5)
    v_mfma_f32_16x16x32_bf16 v[24:27], v[68:71], v[64:67], v[24:27]
    ds_read_b64 v[40:41], v2 offset:1664
    ds_read_b64 v[42:43], v2 offset:1672
    s_waitcnt lgkmcnt(5)
    v_mfma_f32_16x16x32_bf16 v[28:31], v[68:71], v[72:75], v[28:31]
    ds_read_b128 v[44:47], v1 offset:128
    s_waitcnt lgkmcnt(5)
    v_mfma_f32_16x16x32_bf16 v[28:31], v[76:79], v[64:67], v[28:31]
    ds_read_b64 v[48:49], v2 offset:1152
    v_mfma_f32_16x16x32_bf16 v[32:35], v[76:79], v[72:75], v[32:35]
    ds_read_b64 v[50:51], v2 offset:1160
    s_waitcnt lgkmcnt(6)
    v_mfma_f32_16x16x32_bf16 v[32:35], v[80:83], v[64:67], v[32:35]
    ds_read_b128 v[52:55], v1 offset:640
    v_mfma_f32_16x16x32_bf16 v[36:39], v[80:83], v[72:75], v[36:39]
    ds_read_b128 v[56:59], v1 offset:1152
    s_waitcnt lgkmcnt(7)
    v_mfma_f32_16x16x32_bf16 v[36:39], v[84:87], v[64:67], v[36:39]
    ds_read_b128 v[60:63], v1 offset:1664
    s_waitcnt lgkmcnt(5)
    v_mfma_f32_16x16x32_bf16 v[8:11], v[44:47], v[40:43], v[8:11]
    ds_read_b64 v[64:65], v2 offset:6048
    ds_read_b64 v[66:67], v2 offset:6056
    s_waitcnt lgkmcnt(5)
    v_mfma_f32_16x16x32_bf16 v[12:15], v[44:47], v[48:51], v[12:15]
    ds_read_b128 v[68:71], v1 offset:5184
    s_waitcnt lgkmcnt(5)
    v_mfma_f32_16x16x32_bf16 v[12:15], v[52:55], v[40:43], v[12:15]
    ds_read_b64 v[72:73], v2 offset:5536
    v_mfma_f32_16x16x32_bf16 v[16:19], v[52:55], v[48:51], v[16:19]
    ds_read_b64 v[74:75], v2 offset:5544
    s_waitcnt lgkmcnt(6)
    v_mfma_f32_16x16x32_bf16 v[16:19], v[56:59], v[40:43], v[16:19]
    ds_read_b128 v[76:79], v1 offset:5696
    v_mfma_f32_16x16x32_bf16 v[20:23], v[56:59], v[48:51], v[20:23]
    ds_read_b128 v[80:83], v1 offset:6208
    s_waitcnt lgkmcnt(7)
    v_mfma_f32_16x16x32_bf16 v[20:23], v[60:63], v[40:43], v[20:23]
    ds_read_b128 v[84:87], v1 offset:6720
    s_waitcnt lgkmcnt(5)
    v_mfma_f32_16x16x32_bf16 v[24:27], v[68:71], v[64:67], v[24:27]
    ds_read_b64 v[40:41], v2 offset:1728
    ds_read_b64 v[42:43], v2 offset:1736
    s_waitcnt lgkmcnt(5)
    v_mfma_f32_16x16x32_bf16 v[28:31], v[68:71], v[72:75], v[28:31]
    ds_read_b128 v[44:47], v1 offset:192
    s_waitcnt lgkmcnt(5)
    v_mfma_f32_16x16x32_bf16 v[28:31], v[76:79], v[64:67], v[28:31]
    ds_read_b64 v[48:49], v2 offset:1216
    v_mfma_f32_16x16x32_bf16 v[32:35], v[76:79], v[72:75], v[32:35]
    ds_read_b64 v[50:51], v2 offset:1224
    s_waitcnt lgkmcnt(6)
    v_mfma_f32_16x16x32_bf16 v[32:35], v[80:83], v[64:67], v[32:35]
    ds_read_b128 v[52:55], v1 offset:704
    v_mfma_f32_16x16x32_bf16 v[36:39], v[80:83], v[72:75], v[36:39]
    ds_read_b128 v[56:59], v1 offset:1216
    s_waitcnt lgkmcnt(7)
    v_mfma_f32_16x16x32_bf16 v[36:39], v[84:87], v[64:67], v[36:39]
    ds_read_b128 v[60:63], v1 offset:1728
    s_waitcnt lgkmcnt(5)
    v_mfma_f32_16x16x32_bf16 v[8:11], v[44:47], v[40:43], v[8:11]
    ds_read_b64 v[64:65], v2 offset:6112
    ds_read_b64 v[66:67], v2 offset:6120
    s_waitcnt lgkmcnt(5)
    v_mfma_f32_16x16x32_bf16 v[12:15], v[44:47], v[48:51], v[12:15]
    ds_read_b128 v[68:71], v1 offset:5248
    s_waitcnt lgkmcnt(5)
    v_mfma_f32_16x16x32_bf16 v[12:15], v[52:55], v[40:43], v[12:15]
    ds_read_b64 v[72:73], v2 offset:5600
    v_mfma_f32_16x16x32_bf16 v[16:19], v[52:55], v[48:51], v[16:19]
    ds_read_b64 v[74:75], v2 offset:5608
    s_waitcnt lgkmcnt(6)
    v_mfma_f32_16x16x32_bf16 v[16:19], v[56:59], v[40:43], v[16:19]
    ds_read_b128 v[76:79], v1 offset:5760
    v_mfma_f32_16x16x32_bf16 v[20:23], v[56:59], v[48:51], v[20:23]
    ds_read_b128 v[80:83], v1 offset:6272
    s_waitcnt lgkmcnt(7)
    v_mfma_f32_16x16x32_bf16 v[20:23], v[60:63], v[40:43], v[20:23]
    ds_read_b128 v[84:87], v1 offset:6784
    s_waitcnt lgkmcnt(5)
    v_mfma_f32_16x16x32_bf16 v[24:27], v[68:71], v[64:67], v[24:27]
    ds_read_b64 v[40:41], v2 offset:1792
    ds_read_b64 v[42:43], v2 offset:1800
    s_waitcnt lgkmcnt(5)
    v_mfma_f32_16x16x32_bf16 v[28:31], v[68:71], v[72:75], v[28:31]
    ds_read_b128 v[44:47], v1 offset:256
    s_waitcnt lgkmcnt(5)
    v_mfma_f32_16x16x32_bf16 v[28:31], v[76:79], v[64:67], v[28:31]
    ds_read_b64 v[48:49], v2 offset:1280
    v_mfma_f32_16x16x32_bf16 v[32:35], v[76:79], v[72:75], v[32:35]
    ds_read_b64 v[50:51], v2 offset:1288
    s_waitcnt lgkmcnt(6)
    v_mfma_f32_16x16x32_bf16 v[32:35], v[80:83], v[64:67], v[32:35]
    ds_read_b128 v[52:55], v1 offset:768
    v_mfma_f32_16x16x32_bf16 v[36:39], v[80:83], v[72:75], v[36:39]
    ds_read_b128 v[56:59], v1 offset:1280
    s_waitcnt lgkmcnt(7)
    v_mfma_f32_16x16x32_bf16 v[36:39], v[84:87], v[64:67], v[36:39]
    ds_read_b128 v[60:63], v1 offset:1792
    s_waitcnt lgkmcnt(5)
    v_mfma_f32_16x16x32_bf16 v[8:11], v[44:47], v[40:43], v[8:11]
    ds_read_b64 v[64:65], v2 offset:6176
    ds_read_b64 v[66:67], v2 offset:6184
    s_waitcnt lgkmcnt(5)
    v_mfma_f32_16x16x32_bf16 v[12:15], v[44:47], v[48:51], v[12:15]
    ds_read_b128 v[68:71], v1 offset:5312
    s_waitcnt lgkmcnt(5)
    v_mfma_f32_16x16x32_bf16 v[12:15], v[52:55], v[40:43], v[12:15]
    ds_read_b64 v[72:73], v2 offset:5664
    v_mfma_f32_16x16x32_bf16 v[16:19], v[52:55], v[48:51], v[16:19]
    ds_read_b64 v[74:75], v2 offset:5672
    s_waitcnt lgkmcnt(6)
    v_mfma_f32_16x16x32_bf16 v[16:19], v[56:59], v[40:43], v[16:19]
    ds_read_b128 v[76:79], v1 offset:5824
    v_mfma_f32_16x16x32_bf16 v[20:23], v[56:59], v[48:51], v[20:23]
    ds_read_b128 v[80:83], v1 offset:6336
    s_waitcnt lgkmcnt(7)
    v_mfma_f32_16x16x32_bf16 v[20:23], v[60:63], v[40:43], v[20:23]
    ds_read_b128 v[84:87], v1 offset:6848
    s_waitcnt lgkmcnt(5)
    v_mfma_f32_16x16x32_bf16 v[24:27], v[68:71], v[64:67], v[24:27]
    ds_read_b64 v[40:41], v2 offset:1856
    ds_read_b64 v[42:43], v2 offset:1864
    s_waitcnt lgkmcnt(5)
    v_mfma_f32_16x16x32_bf16 v[28:31], v[68:71], v[72:75], v[28:31]
    ds_read_b128 v[44:47], v1 offset:320
    s_waitcnt lgkmcnt(5)
    v_mfma_f32_16x16x32_bf16 v[28:31], v[76:79], v[64:67], v[28:31]
    ds_read_b64 v[48:49], v2 offset:1344
    v_mfma_f32_16x16x32_bf16 v[32:35], v[76:79], v[72:75], v[32:35]
    ds_read_b64 v[50:51], v2 offset:1352
    s_waitcnt lgkmcnt(6)
    v_mfma_f32_16x16x32_bf16 v[32:35], v[80:83], v[64:67], v[32:35]
    ds_read_b128 v[52:55], v1 offset:832
    v_mfma_f32_16x16x32_bf16 v[36:39], v[80:83], v[72:75], v[36:39]
    ds_read_b128 v[56:59], v1 offset:1344
    s_waitcnt lgkmcnt(7)
    v_mfma_f32_16x16x32_bf16 v[36:39], v[84:87], v[64:67], v[36:39]
    ds_read_b128 v[60:63], v1 offset:1856
    s_waitcnt lgkmcnt(5)
    v_mfma_f32_16x16x32_bf16 v[8:11], v[44:47], v[40:43], v[8:11]
    ds_read_b64 v[64:65], v2 offset:6240
    ds_read_b64 v[66:67], v2 offset:6248
    s_waitcnt lgkmcnt(5)
    v_mfma_f32_16x16x32_bf16 v[12:15], v[44:47], v[48:51], v[12:15]
    ds_read_b128 v[68:71], v1 offset:5376
    s_waitcnt lgkmcnt(5)
    v_mfma_f32_16x16x32_bf16 v[12:15], v[52:55], v[40:43], v[12:15]
    ds_read_b64 v[72:73], v2 offset:5728
    v_mfma_f32_16x16x32_bf16 v[16:19], v[52:55], v[48:51], v[16:19]
    ds_read_b64 v[74:75], v2 offset:5736
    s_waitcnt lgkmcnt(6)
    v_mfma_f32_16x16x32_bf16 v[16:19], v[56:59], v[40:43], v[16:19]
    ds_read_b128 v[76:79], v1 offset:5888
    v_mfma_f32_16x16x32_bf16 v[20:23], v[56:59], v[48:51], v[20:23]
    ds_read_b128 v[80:83], v1 offset:6400
    s_waitcnt lgkmcnt(7)
    v_mfma_f32_16x16x32_bf16 v[20:23], v[60:63], v[40:43], v[20:23]
    ds_read_b128 v[84:87], v1 offset:6912
    s_waitcnt lgkmcnt(5)
    v_mfma_f32_16x16x32_bf16 v[24:27], v[68:71], v[64:67], v[24:27]
    ds_read_b64 v[40:41], v2 offset:1920
    ds_read_b64 v[42:43], v2 offset:1928
    s_waitcnt lgkmcnt(5)
    v_mfma_f32_16x16x32_bf16 v[28:31], v[68:71], v[72:75], v[28:31]
    ds_read_b128 v[44:47], v1 offset:384
    s_waitcnt lgkmcnt(5)
    v_mfma_f32_16x16x32_bf16 v[28:31], v[76:79], v[64:67], v[28:31]
    ds_read_b64 v[48:49], v2 offset:1408
    v_mfma_f32_16x16x32_bf16 v[32:35], v[76:79], v[72:75], v[32:35]
    ds_read_b64 v[50:51], v2 offset:1416
    s_waitcnt lgkmcnt(6)
    v_mfma_f32_16x16x32_bf16 v[32:35], v[80:83], v[64:67], v[32:35]
    ds_read_b128 v[52:55], v1 offset:896
    v_mfma_f32_16x16x32_bf16 v[36:39], v[80:83], v[72:75], v[36:39]
    ds_read_b128 v[56:59], v1 offset:1408
    s_waitcnt lgkmcnt(7)
    v_mfma_f32_16x16x32_bf16 v[36:39], v[84:87], v[64:67], v[36:39]
    ds_read_b128 v[60:63], v1 offset:1920
    s_waitcnt lgkmcnt(5)
    v_mfma_f32_16x16x32_bf16 v[8:11], v[44:47], v[40:43], v[8:11]
    ds_read_b64 v[64:65], v2 offset:6304
    ds_read_b64 v[66:67], v2 offset:6312
    s_waitcnt lgkmcnt(5)
    v_mfma_f32_16x16x32_bf16 v[12:15], v[44:47], v[48:51], v[12:15]
    ds_read_b128 v[68:71], v1 offset:5440
    s_waitcnt lgkmcnt(5)
    v_mfma_f32_16x16x32_bf16 v[12:15], v[52:55], v[40:43], v[12:15]
    ds_read_b64 v[72:73], v2 offset:5792
    v_mfma_f32_16x16x32_bf16 v[16:19], v[52:55], v[48:51], v[16:19]
    ds_read_b64 v[74:75], v2 offset:5800
    s_waitcnt lgkmcnt(6)
    v_mfma_f32_16x16x32_bf16 v[16:19], v[56:59], v[40:43], v[16:19]
    ds_read_b128 v[76:79], v1 offset:5952
    v_mfma_f32_16x16x32_bf16 v[20:23], v[56:59], v[48:51], v[20:23]
    ds_read_b128 v[80:83], v1 offset:6464
    s_waitcnt lgkmcnt(7)
    v_mfma_f32_16x16x32_bf16 v[20:23], v[60:63], v[40:43], v[20:23]
    ds_read_b128 v[84:87], v1 offset:6976
    s_waitcnt lgkmcnt(5)
    v_mfma_f32_16x16x32_bf16 v[24:27], v[68:71], v[64:67], v[24:27]
    ds_read_b64 v[40:41], v2 offset:1984
    ds_read_b64 v[42:43], v2 offset:1992
    s_waitcnt lgkmcnt(5)
    v_mfma_f32_16x16x32_bf16 v[28:31], v[68:71], v[72:75], v[28:31]
    ds_read_b128 v[44:47], v1 offset:448
    s_waitcnt lgkmcnt(5)
    v_mfma_f32_16x16x32_bf16 v[28:31], v[76:79], v[64:67], v[28:31]
    ds_read_b64 v[48:49], v2 offset:1472
    v_mfma_f32_16x16x32_bf16 v[32:35], v[76:79], v[72:75], v[32:35]
    ds_read_b64 v[50:51], v2 offset:1480
    s_waitcnt lgkmcnt(6)
    v_mfma_f32_16x16x32_bf16 v[32:35], v[80:83], v[64:67], v[32:35]
    ds_read_b128 v[52:55], v1 offset:960
    v_mfma_f32_16x16x32_bf16 v[36:39], v[80:83], v[72:75], v[36:39]
    ds_read_b128 v[56:59], v1 offset:1472
    s_waitcnt lgkmcnt(7)
    v_mfma_f32_16x16x32_bf16 v[36:39], v[84:87], v[64:67], v[36:39]
    ds_read_b128 v[60:63], v1 offset:1984
    s_waitcnt lgkmcnt(5)
    v_mfma_f32_16x16x32_bf16 v[8:11], v[44:47], v[40:43], v[8:11]
    ds_read_b64 v[64:65], v2 offset:6368
    ds_read_b64 v[66:67], v2 offset:6376
    s_waitcnt lgkmcnt(5)
    v_mfma_f32_16x16x32_bf16 v[12:15], v[44:47], v[48:51], v[12:15]
    ds_read_b128 v[68:71], v1 offset:5504
    s_waitcnt lgkmcnt(5)
    v_mfma_f32_16x16x32_bf16 v[12:15], v[52:55], v[40:43], v[12:15]
    ds_read_b64 v[72:73], v2 offset:5856
    v_mfma_f32_16x16x32_bf16 v[16:19], v[52:55], v[48:51], v[16:19]
    ds_read_b64 v[74:75], v2 offset:5864
    s_waitcnt lgkmcnt(6)
    v_mfma_f32_16x16x32_bf16 v[16:19], v[56:59], v[40:43], v[16:19]
    ds_read_b128 v[76:79], v1 offset:6016
    v_mfma_f32_16x16x32_bf16 v[20:23], v[56:59], v[48:51], v[20:23]
    ds_read_b128 v[80:83], v1 offset:6528
    s_waitcnt lgkmcnt(7)
    v_mfma_f32_16x16x32_bf16 v[20:23], v[60:63], v[40:43], v[20:23]
    ds_read_b128 v[84:87], v1 offset:7040
    s_waitcnt lgkmcnt(5)
    v_mfma_f32_16x16x32_bf16 v[24:27], v[68:71], v[64:67], v[24:27]
    s_waitcnt lgkmcnt(3)
    v_mfma_f32_16x16x32_bf16 v[28:31], v[68:71], v[72:75], v[28:31]
    s_waitcnt lgkmcnt(2)
    v_mfma_f32_16x16x32_bf16 v[28:31], v[76:79], v[64:67], v[28:31]
    v_mfma_f32_16x16x32_bf16 v[32:35], v[76:79], v[72:75], v[32:35]
    s_waitcnt lgkmcnt(1)
    v_mfma_f32_16x16x32_bf16 v[32:35], v[80:83], v[64:67], v[32:35]
    v_mfma_f32_16x16x32_bf16 v[36:39], v[80:83], v[72:75], v[36:39]
    s_waitcnt lgkmcnt(0)
    v_mfma_f32_16x16x32_bf16 v[36:39], v[84:87], v[64:67], v[36:39]
    s_nop 7
    ds_write_b64 v3, v[8:9] offset:1024
    ds_write_b64 v3, v[10:11] offset:1152
    ds_write_b64 v3, v[12:13] offset:3200
    ds_write_b64 v3, v[14:15] offset:3328
    ds_write_b64 v3, v[24:25] offset:5408
    ds_write_b64 v3, v[26:27] offset:5536
    ds_write_b64 v3, v[28:29] offset:7584
    ds_write_b64 v3, v[30:31] offset:7712
    s_waitcnt lgkmcnt(0)
    s_mov_b64 exec, 1
    ds_add_u32 v4, v5 offset:32
    s_mov_b64 exec, -1
    s_setprio 0
    ds_read_b128 v[44:47], v1 offset:0
    ds_read_b128 v[52:55], v1 offset:512
    s_mov_b64 exec, 1
L_xwait_9:
    ds_read_b64 v[120:121], v4 offset:8
    s_waitcnt lgkmcnt(0)
    v_and_b32 v120, v120, v121
    s_nop 0
    v_readfirstlane_b32 s7, v120
    s_bitcmp1_b32 s7, 2
    s_cbranch_scc1 L_xwait_9_done
    s_sleep 1
    s_branch L_xwait_9
L_xwait_9_done:
    s_mov_b64 exec, -1
    ds_read_b64 v[40:41], v2 offset:512
    ds_read_b64 v[42:43], v2 offset:520
    ds_read_b64 v[48:49], v2 offset:0
    ds_read_b64 v[50:51], v2 offset:8
    s_waitcnt lgkmcnt(2)
    v_mfma_f32_16x16x32_bf16 v[16:19], v[44:47], v[40:43], v[16:19]
    ds_read_b64 v[56:57], v2 offset:4896
    ds_read_b64 v[58:59], v2 offset:4904
    s_waitcnt lgkmcnt(2)
    v_mfma_f32_16x16x32_bf16 v[20:23], v[44:47], v[48:51], v[20:23]
    ds_read_b128 v[60:63], v1 offset:5056
    ds_read_b64 v[64:65], v2 offset:4384
    v_mfma_f32_16x16x32_bf16 v[20:23], v[52:55], v[40:43], v[20:23]
    ds_read_b64 v[66:67], v2 offset:4392
    ds_read_b128 v[68:71], v1 offset:5568
    s_waitcnt lgkmcnt(3)
    v_mfma_f32_16x16x32_bf16 v[32:35], v[60:63], v[56:59], v[32:35]
    ds_read_b64 v[40:41], v2 offset:576
    ds_read_b64 v[42:43], v2 offset:584
    s_waitcnt lgkmcnt(3)
    v_mfma_f32_16x16x32_bf16 v[36:39], v[60:63], v[64:67], v[36:39]
    ds_read_b128 v[44:47], v1 offset:64
    ds_read_b64 v[48:49], v2 offset:64
    s_waitcnt lgkmcnt(4)
    v_mfma_f32_16x16x32_bf16 v[36:39], v[68:71], v[56:59], v[36:39]
    ds_read_b64 v[50:51], v2 offset:72
    ds_read_b128 v[52:55], v1 offset:576
    s_waitcnt lgkmcnt(3)
    v_mfma_f32_16x16x32_bf16 v[16:19], v[44:47], v[40:43], v[16:19]
    ds_read_b64 v[56:57], v2 offset:4960
    ds_read_b64 v[58:59], v2 offset:4968
    s_waitcnt lgkmcnt(3)
    v_mfma_f32_16x16x32_bf16 v[20:23], v[44:47], v[48:51], v[20:23]
    ds_read_b128 v[60:63], v1 offset:5120
    ds_read_b64 v[64:65], v2 offset:4448
    s_waitcnt lgkmcnt(4)
    v_mfma_f32_16x16x32_bf16 v[20:23], v[52:55], v[40:43], v[20:23]
    ds_read_b64 v[66:67], v2 offset:4456
    ds_read_b128 v[68:71], v1 offset:5632
    s_waitcnt lgkmcnt(3)
    v_mfma_f32_16x16x32_bf16 v[32:35], v[60:63], v[56:59], v[32:35]
    ds_read_b64 v[40:41], v2 offset:640
    ds_read_b64 v[42:43], v2 offset:648
    s_waitcnt lgkmcnt(3)
    v_mfma_f32_16x16x32_bf16 v[36:39], v[60:63], v[64:67], v[36:39]
    ds_read_b128 v[44:47], v1 offset:128
    ds_read_b64 v[48:49], v2 offset:128
    s_waitcnt lgkmcnt(4)
    v_mfma_f32_16x16x32_bf16 v[36:39], v[68:71], v[56:59], v[36:39]
    ds_read_b64 v[50:51], v2 offset:136
    ds_read_b128 v[52:55], v1 offset:640
    s_waitcnt lgkmcnt(3)
    v_mfma_f32_16x16x32_bf16 v[16:19], v[44:47], v[40:43], v[16:19]
    ds_read_b64 v[56:57], v2 offset:5024
    ds_read_b64 v[58:59], v2 offset:5032
    s_waitcnt lgkmcnt(3)
    v_mfma_f32_16x16x32_bf16 v[20:23], v[44:47], v[48:51], v[20:23]
    ds_read_b128 v[60:63], v1 offset:5184
    ds_read_b64 v[64:65], v2 offset:4512
    s_waitcnt lgkmcnt(4)
    v_mfma_f32_16x16x32_bf16 v[20:23], v[52:55], v[40:43], v[20:23]
    ds_read_b64 v[66:67], v2 offset:4520
    ds_read_b128 v[68:71], v1 offset:5696
    s_waitcnt lgkmcnt(3)
    v_mfma_f32_16x16x32_bf16 v[32:35], v[60:63], v[56:59], v[32:35]
    ds_read_b64 v[40:41], v2 offset:704
    ds_read_b64 v[42:43], v2 offset:712
    s_waitcnt lgkmcnt(3)
    v_mfma_f32_16x16x32_bf16 v[36:39], v[60:63], v[64:67], v[36:39]
    ds_read_b128 v[44:47], v1 offset:192
    ds_read_b64 v[48:49], v2 offset:192
    s_waitcnt lgkmcnt(4)
    v_mfma_f32_16x16x32_bf16 v[36:39], v[68:71], v[56:59], v[36:39]
    ds_read_b64 v[50:51], v2 offset:200
    ds_read_b128 v[52:55], v1 offset:704
    s_waitcnt lgkmcnt(3)
    v_mfma_f32_16x16x32_bf16 v[16:19], v[44:47], v[40:43], v[16:19]
    ds_read_b64 v[56:57], v2 offset:5088
    ds_read_b64 v[58:59], v2 offset:5096
    s_waitcnt lgkmcnt(3)
    v_mfma_f32_16x16x32_bf16 v[20:23], v[44:47], v[48:51], v[20:23]
    ds_read_b128 v[60:63], v1 offset:5248
    ds_read_b64 v[64:65], v2 offset:4576
    s_waitcnt lgkmcnt(4)
    v_mfma_f32_16x16x32_bf16 v[20:23], v[52:55], v[40:43], v[20:23]
    ds_read_b64 v[66:67], v2 offset:4584
    ds_read_b128 v[68:71], v1 offset:5760
    s_waitcnt lgkmcnt(3)
    v_mfma_f32_16x16x32_bf16 v[32:35], v[60:63], v[56:59], v[32:35]
    ds_read_b64 v[40:41], v2 offset:768
    ds_read_b64 v[42:43], v2 offset:776
    s_waitcnt lgkmcnt(3)
    v_mfma_f32_16x16x32_bf16 v[36:39], v[60:63], v[64:67], v[36:39]
    ds_read_b128 v[44:47], v1 offset:256
    ds_read_b64 v[48:49], v2 offset:256
    s_waitcnt lgkmcnt(4)
    v_mfma_f32_16x16x32_bf16 v[36:39], v[68:71], v[56:59], v[36:39]
    ds_read_b64 v[50:51], v2 offset:264
    ds_read_b128 v[52:55], v1 offset:768
    s_waitcnt lgkmcnt(3)
    v_mfma_f32_16x16x32_bf16 v[16:19], v[44:47], v[40:43], v[16:19]
    ds_read_b64 v[56:57], v2 offset:5152
    ds_read_b64 v[58:59], v2 offset:5160
    s_waitcnt lgkmcnt(3)
    v_mfma_f32_16x16x32_bf16 v[20:23], v[44:47], v[48:51], v[20:23]
    ds_read_b128 v[60:63], v1 offset:5312
    ds_read_b64 v[64:65], v2 offset:4640
    s_waitcnt lgkmcnt(4)
    v_mfma_f32_16x16x32_bf16 v[20:23], v[52:55], v[40:43], v[20:23]
    ds_read_b64 v[66:67], v2 offset:4648
    ds_read_b128 v[68:71], v1 offset:5824
    s_waitcnt lgkmcnt(3)
    v_mfma_f32_16x16x32_bf16 v[32:35], v[60:63], v[56:59], v[32:35]
    ds_read_b64 v[40:41], v2 offset:832
    ds_read_b64 v[42:43], v2 offset:840
    s_waitcnt lgkmcnt(3)
    v_mfma_f32_16x16x32_bf16 v[36:39], v[60:63], v[64:67], v[36:39]
    ds_read_b128 v[44:47], v1 offset:320
    ds_read_b64 v[48:49], v2 offset:320
    s_waitcnt lgkmcnt(4)
    v_mfma_f32_16x16x32_bf16 v[36:39], v[68:71], v[56:59], v[36:39]
    ds_read_b64 v[50:51], v2 offset:328
    ds_read_b128 v[52:55], v1 offset:832
    s_waitcnt lgkmcnt(3)
    v_mfma_f32_16x16x32_bf16 v[16:19], v[44:47], v[40:43], v[16:19]
    ds_read_b64 v[56:57], v2 offset:5216
    ds_read_b64 v[58:59], v2 offset:5224
    s_waitcnt lgkmcnt(3)
    v_mfma_f32_16x16x32_bf16 v[20:23], v[44:47], v[48:51], v[20:23]
    ds_read_b128 v[60:63], v1 offset:5376
    ds_read_b64 v[64:65], v2 offset:4704
    s_waitcnt lgkmcnt(4)
    v_mfma_f32_16x16x32_bf16 v[20:23], v[52:55], v[40:43], v[20:23]
    ds_read_b64 v[66:67], v2 offset:4712
    ds_read_b128 v[68:71], v1 offset:5888
    s_waitcnt lgkmcnt(3)
    v_mfma_f32_16x16x32_bf16 v[32:35], v[60:63], v[56:59], v[32:35]
    ds_read_b64 v[40:41], v2 offset:896
    ds_read_b64 v[42:43], v2 offset:904
    s_waitcnt lgkmcnt(3)
    v_mfma_f32_16x16x32_bf16 v[36:39], v[60:63], v[64:67], v[36:39]
    ds_read_b128 v[44:47], v1 offset:384
    ds_read_b64 v[48:49], v2 offset:384
    s_waitcnt lgkmcnt(4)
    v_mfma_f32_16x16x32_bf16 v[36:39], v[68:71], v[56:59], v[36:39]
    ds_read_b64 v[50:51], v2 offset:392
    ds_read_b128 v[52:55], v1 offset:896
    s_waitcnt lgkmcnt(3)
    v_mfma_f32_16x16x32_bf16 v[16:19], v[44:47], v[40:43], v[16:19]
    ds_read_b64 v[56:57], v2 offset:5280
    ds_read_b64 v[58:59], v2 offset:5288
    s_waitcnt lgkmcnt(3)
    v_mfma_f32_16x16x32_bf16 v[20:23], v[44:47], v[48:51], v[20:23]
    ds_read_b128 v[60:63], v1 offset:5440
    ds_read_b64 v[64:65], v2 offset:4768
    s_waitcnt lgkmcnt(4)
    v_mfma_f32_16x16x32_bf16 v[20:23], v[52:55], v[40:43], v[20:23]
    ds_read_b64 v[66:67], v2 offset:4776
    ds_read_b128 v[68:71], v1 offset:5952
    s_waitcnt lgkmcnt(3)
    v_mfma_f32_16x16x32_bf16 v[32:35], v[60:63], v[56:59], v[32:35]
    ds_read_b64 v[40:41], v2 offset:960
    ds_read_b64 v[42:43], v2 offset:968
    s_waitcnt lgkmcnt(3)
    v_mfma_f32_16x16x32_bf16 v[36:39], v[60:63], v[64:67], v[36:39]
    ds_read_b128 v[44:47], v1 offset:448
    ds_read_b64 v[48:49], v2 offset:448
    s_waitcnt lgkmcnt(4)
    v_mfma_f32_16x16x32_bf16 v[36:39], v[68:71], v[56:59], v[36:39]
    ds_read_b64 v[50:51], v2 offset:456
    ds_read_b128 v[52:55], v1 offset:960
    s_waitcnt lgkmcnt(3)
    v_mfma_f32_16x16x32_bf16 v[16:19], v[44:47], v[40:43], v[16:19]
    ds_read_b64 v[56:57], v2 offset:5344
    ds_read_b64 v[58:59], v2 offset:5352
    s_waitcnt lgkmcnt(3)
    v_mfma_f32_16x16x32_bf16 v[20:23], v[44:47], v[48:51], v[20:23]
    ds_read_b128 v[60:63], v1 offset:5504
    ds_read_b64 v[64:65], v2 offset:4832
    s_waitcnt lgkmcnt(4)
    v_mfma_f32_16x16x32_bf16 v[20:23], v[52:55], v[40:43], v[20:23]
    ds_read_b64 v[66:67], v2 offset:4840
    ds_read_b128 v[68:71], v1 offset:6016
    s_waitcnt lgkmcnt(3)
    v_mfma_f32_16x16x32_bf16 v[32:35], v[60:63], v[56:59], v[32:35]
    s_waitcnt lgkmcnt(1)
    v_mfma_f32_16x16x32_bf16 v[36:39], v[60:63], v[64:67], v[36:39]
    s_waitcnt lgkmcnt(0)
    v_mfma_f32_16x16x32_bf16 v[36:39], v[68:71], v[56:59], v[36:39]
    s_nop 7
    ds_write_b64 v3, v[16:17] offset:0
    ds_write_b64 v3, v[18:19] offset:128
    ds_write_b64 v3, v[20:21] offset:2176
    ds_write_b64 v3, v[22:23] offset:2304
    ds_write_b64 v3, v[32:33] offset:4384
    ds_write_b64 v3, v[34:35] offset:4512
    ds_write_b64 v3, v[36:37] offset:6560
    ds_write_b64 v3, v[38:39] offset:6688
    s_waitcnt lgkmcnt(0)
    s_mov_b64 exec, 1
    ds_add_u32 v4, v5 offset:36
    s_mov_b64 exec, -1
    s_endpgm
L_pf:
    s_xor_b32 s3, s3, 8
    s_waitcnt lgkmcnt(0)
    s_mov_b32 s12, s30
    s_and_b32 s13, s31, 0xffff
    s_mov_b32 s14, 2621440
    s_mov_b32 s15, 0x20000
    s_mov_b32 s16, s32
    s_and_b32 s17, s33, 0xffff
    s_mov_b32 s18, 2621440
    s_mov_b32 s19, 0x20000
    s_mov_b32 s20, s28
    s_and_b32 s21, s29, 0xffff
    s_mov_b32 s22, 2621440
    s_mov_b32 s23, 0x20000
    s_lshl_b32 s46, s3, 1
    s_add_u32 s46, s46, s5
    s_sub_u32 s46, s46, 30
    s_lshl_b32 s7, s46, 6
    v_add_u32 v8, s7, v0
    s_mov_b32 s7, 0xAAAB
    v_mul_u32_u24 v9, s7, v8
    v_lshrrev_b32 v9, 17, v9
    v_mul_u32_u24 v10, 3, v9
    v_sub_u32 v10, v8, v10
    v_mul_u32_u24 v9, 1280, v9
    v_lshlrev_b32 v10, 7, v10
    s_add_u32 s7, s88, 0
    v_add3_u32 v8, v9, v10, s7
    s_lshl_b32 s7, s3, 6
    v_add_u32 v11, s7, v0
    s_mov_b32 s7, 0xAAAB
    v_mul_u32_u24 v9, s7, v11
    v_lshrrev_b32 v9, 17, v9
    v_mul_u32_u24 v10, 3, v9
    v_sub_u32 v10, v11, v10
    v_mul_u32_u24 v9, 1280, v9
    v_lshlrev_b32 v10, 7, v10
    s_add_u32 s7, s88, 0
    v_add3_u32 v11, v9, v10, s7
    s_cmp_eq_u32 s5, 30
    s_cselect_b32 s40, s12, s16
    s_cselect_b32 s41, s13, s17
    s_mov_b32 s42, 2621440
    s_mov_b32 s43, 0x20000
    s_mov_b32 s7, 1310720
    buffer_load_dword v20, v8, s[12:15], s7 offen
    s_barrier
    s_mov_b32 s7, 1310720
    buffer_load_dword v21, v8, s[16:19], s7 offen
    s_barrier
    s_mov_b32 s7, 1310720
    buffer_load_dword v22, v8, s[20:23], s7 offen
    s_barrier
    s_mov_b32 s7, 2183680
    buffer_load_dword v23, v8, s[20:23], s7 offen
    s_barrier
    s_waitcnt vmcnt(0)
L_end:
    s_endpgm
.section .rodata,"a"
.p2align 6
.amdhsa_kernel concat_heads__ssm_conv_h3__ssm_conv_h3__prompt_kernel
  .amdhsa_next_free_vgpr 128
  .amdhsa_next_free_sgpr 102
  .amdhsa_accum_offset 128
  .amdhsa_group_segment_fixed_size 0
  .amdhsa_kernarg_size 120
  .amdhsa_user_sgpr_count 2
  .amdhsa_user_sgpr_kernarg_segment_ptr 1
  .amdhsa_system_sgpr_workgroup_id_x 1
  .amdhsa_float_denorm_mode_32 3
.end_amdhsa_kernel
```
